```python
import torch

def _softmax(x, axis=-1):
    return torch.softmax(x, dim=axis)

def _gelu(x):
    return torch.nn.functional.gelu(x, approximate='tanh')

def _silu(x):
    return torch.nn.functional.silu(x)

def _sigmoid(x):
    return torch.sigmoid(x)

def _layernorm(x, axis=-1, eps=1e-05):
    m = x.mean(dim=axis, keepdim=True)
    v = x.var(dim=axis, keepdim=True, unbiased=False)
    return (x - m) / torch.sqrt(v + eps)

def _scatter_add(tgt, idx, src, axis=0):
    return tgt.clone().index_add_(axis, idx, src)

def _segment_sum(src, seg, n):
    out = torch.zeros((n,) + src.shape[1:], dtype=src.dtype)
    return out.index_add_(0, seg, src)

def _pad(x, pw):
    flat = tuple((v for pair in reversed(pw) for v in pair))
    return torch.nn.functional.pad(x, flat)
kernel_name = 'adaLN_cond__linear_kernel_hedgehog__glu_gated_reglu__prompt'

def setup_inputs():

    _w = lambda a: (lambda t: t.to(torch.bfloat16) if t.is_floating_point() else t)(torch.as_tensor(a))

    def _A_setup():
        B, S, D, H = (1, 2048, 512, 32)
        Dh = D // H
        return {'x': _w((lambda *s: torch.randn(*s, dtype=torch.bfloat16) * 0.05)(B, S, D)), 'wqkv': _w((lambda *s: torch.randn(*s, dtype=torch.bfloat16) * 0.4)(D, 3 * D)), 'w_phi': _w((lambda *s: torch.randn(*s, dtype=torch.bfloat16) * 0.4)(H, Dh, Dh) * Dh ** (-0.5)), 'wo': _w((lambda *s: torch.randn(*s, dtype=torch.bfloat16) * 0.05)(D, D))}
    _A_in = _A_setup()

    def _B_setup():
        B, S, D, F = (1, 2048, 512, 1376)
        return {'x': _w((lambda *s: torch.randn(*s, dtype=torch.bfloat16) * 0.05)(B, S, D)), 'W_gate': _w((lambda *s: torch.randn(*s, dtype=torch.bfloat16) * 0.8)(D, F) * (2.0 / D) ** 0.5), 'W_up': _w((lambda *s: torch.randn(*s, dtype=torch.bfloat16) * 0.8)(D, F) * (2.0 / D) ** 0.5), 'W_down': _w((lambda *s: torch.randn(*s, dtype=torch.bfloat16) * 0.8)(F, D) * (1.0 / F) ** 0.5)}
    _B_in = _B_setup()
    return {'A_x': _A_in['x'], 'A_wqkv': _A_in['wqkv'], 'A_w_phi': _A_in['w_phi'], 'A_wo': _A_in['wo'], 'B_x': _B_in['x'], 'B_W_gate': _B_in['W_gate'], 'B_W_up': _B_in['W_up'], 'B_W_down': _B_in['W_down'], 'c': _w((lambda *s: torch.randn(*s, dtype=torch.bfloat16) * 0.2)(1, 512) * 8.0), 'w_mod': _w((lambda *s: torch.randn(*s, dtype=torch.bfloat16) * 0.2)(512, 6 * 512) * 512 ** (-0.5) * 8.0)}

def reference(A_x, A_wqkv, A_w_phi, A_wo, B_x, B_W_gate, B_W_up, B_W_down, c, w_mod):

    def _A_ref(x, wqkv, w_phi, wo):
        B, S, D = x.shape
        H = 32
        Dh = D // H
        qkv = (lambda x, *d: x.permute(*d))((x @ wqkv).reshape(B, S, 3, H, Dh), 2, 0, 3, 1, 4)
        q, k, v = (qkv[0], qkv[1], qkv[2])
        pq = torch.einsum('bhsd,hdf->bhsf', q, w_phi)
        pk = torch.einsum('bhsd,hdf->bhsf', k, w_phi)
        phi_q = torch.concatenate([_softmax(pq, axis=-1), _softmax(-pq, axis=-1)], axis=-1)
        phi_k = torch.concatenate([_softmax(pk, axis=-1), _softmax(-pk, axis=-1)], axis=-1)
        kv = torch.einsum('bhsf,bhsd->bhfd', phi_k, v)
        z = torch.einsum('bhsf->bhf', phi_k)
        num = torch.einsum('bhqf,bhfd->bhqd', phi_q, kv)
        den = torch.einsum('bhqf,bhf->bhq', phi_q, z)[..., None] + 1e-06
        o = num / den
        return (lambda x, *d: x.permute(*d))(o, 0, 2, 1, 3).reshape(B, S, D) @ wo

    def _B_ref(x, W_gate, W_up, W_down):
        gate = torch.einsum('bsd,df->bsf', x, W_gate)
        up = torch.einsum('bsd,df->bsf', x, W_up)
        gate = gate * (lambda x, dt: x.to(dt))(gate > 0, gate.dtype)
        h = gate * up
        return torch.einsum('bsf,fd->bsd', h, W_down)
    x = A_x
    mod = (_silu(c) @ w_mod).reshape(c.shape[0], 6, 1, -1)
    sa, ca, ga, sb, cb, gb = (mod[:, 0].clone(), mod[:, 1].clone(), mod[:, 2].clone(), mod[:, 3].clone(), mod[:, 4].clone(), mod[:, 5].clone())
    h = _layernorm(x, axis=-1) * (1 + ca) + sa
    x = x + ga * _A_ref(h, A_wqkv, A_w_phi, A_wo)
    h = _layernorm(x, axis=-1) * (1 + cb) + sb
    x = x + gb * _B_ref(h, B_W_gate, B_W_up, B_W_down)
    return x
```

```asm
; @launch grid=(256,1,1) block=(512,1,1) lds=163840
.amdgcn_target "amdgcn-amd-amdhsa--gfx950"
.text
.globl adaLN_cond__linear_kernel_hedgehog__glu_gated_reglu__prompt_kernel
.p2align 8
.type adaLN_cond__linear_kernel_hedgehog__glu_gated_reglu__prompt_kernel,@function
adaLN_cond__linear_kernel_hedgehog__glu_gated_reglu__prompt_kernel:
    s_cmp_ge_u32 s2, 256
    s_cbranch_scc1 L_end
    s_load_dwordx8 s[32:39], s[0:1], 64
    s_load_dwordx16 s[16:31], s[0:1], 0
    s_load_dwordx2 s[40:41], s[0:1], 96
    v_lshrrev_b32 v1, 6, v0
    s_and_b32 s72, s2, 7
    v_readfirstlane_b32 s74, v1
    s_lshr_b32 s73, s2, 3
    v_and_b32 v1, 63, v0
    v_lshrrev_b32 v20, 3, v1
    v_and_b32 v22, 7, v1
    v_lshlrev_b32 v24, 4, v22
    v_mul_u32_u24 v21, 6144, v20
    v_lshl_add_u32 v23, v20, 10, v24
    v_add_u32 v21, v21, v24
    v_lshlrev_b32 v20, 1, v20
    s_mov_b32 s50, 0x200000
    s_mov_b32 s51, 0x20000
    s_cmp_lg_u32 s74, 1
    s_cbranch_scc1 L_not1
    s_lshr_b32 s3, s2, 4
    s_and_b32 s4, s2, 15
    s_mul_i32 s5, s3, 196608
    s_lshl_b32 s6, s4, 7
    s_add_u32 s5, s5, s6
    s_add_u32 s7, s5, 49152
    s_add_u32 s8, s5, 98304
    s_add_u32 s9, s5, 147456
    s_lshl_b32 s6, s3, 6
    s_mov_b32 s62, 0x300000
    s_mov_b32 s63, 0x20000
    s_mov_b32 s58, 1024
    s_mov_b32 s59, 0x20000
    s_waitcnt lgkmcnt(0)
    s_mov_b64 s[56:57], s[32:33]
    s_mov_b64 s[60:61], s[34:35]
    buffer_load_ushort v40, v20, s[56:59], s6 offen offset:0
    buffer_load_ushort v41, v20, s[56:59], s6 offen offset:16
    buffer_load_ushort v42, v20, s[56:59], s6 offen offset:32
    buffer_load_ushort v43, v20, s[56:59], s6 offen offset:48
    buffer_load_dwordx4 v[128:131], v21, s[60:63], s5 offen nt
    buffer_load_dwordx4 v[132:135], v21, s[60:63], s7 offen nt
    buffer_load_dwordx4 v[136:139], v21, s[60:63], s8 offen nt
    buffer_load_dwordx4 v[140:143], v21, s[60:63], s9 offen nt
    s_branch L_issued
L_not1:
    s_cmp_lg_u32 s74, 0
    s_cbranch_scc1 L_not0
    s_lshl_b32 s3, s72, 18
    s_lshl_b32 s4, s73, 13
    s_add_u32 s3, s3, s4
    s_waitcnt lgkmcnt(0)
    s_mov_b64 s[48:49], s[16:17]
    buffer_load_dwordx4 v[64:67], v23, s[48:51], s3 offen offset:0 nt
    buffer_load_dwordx4 v[68:71], v23, s[48:51], s3 offen offset:128 nt
    buffer_load_dwordx4 v[72:75], v23, s[48:51], s3 offen offset:256 nt
    buffer_load_dwordx4 v[76:79], v23, s[48:51], s3 offen offset:384 nt
    buffer_load_dwordx4 v[80:83], v23, s[48:51], s3 offen offset:512 nt
    buffer_load_dwordx4 v[84:87], v23, s[48:51], s3 offen offset:640 nt
    buffer_load_dwordx4 v[88:91], v23, s[48:51], s3 offen offset:768 nt
    buffer_load_dwordx4 v[92:95], v23, s[48:51], s3 offen offset:896 nt
    s_branch L_issued
L_not0:
    s_cmp_ge_u32 s74, 4
    s_cbranch_scc1 L_notA
    s_waitcnt lgkmcnt(0)
    s_branch L_issued
L_notA:
    v_and_b32 v19, 31, v1
    v_lshlrev_b32 v10, 10, v19
    v_lshrrev_b32 v24, 5, v1
    v_lshl_add_u32 v10, v24, 4, v10
    s_and_b32 s15, s73, 7
    s_and_b32 s14, s74, 1
    s_bfe_u32 s13, s74, 0x10001
    s_lshr_b32 s8, s73, 3
    s_lshl_b32 s8, s8, 1
    s_add_u32 s8, s8, s14
    s_lshl_b32 s12, s72, 3
    s_add_u32 s12, s12, s8
    s_lshl_b32 s100, s12, 15
    s_lshl_b32 s8, s15, 7
    s_add_u32 s100, s100, s8
    s_lshl_b32 s8, s13, 6
    s_add_u32 s100, s100, s8
    s_getpc_b64 s[10:11]
L_pcref:
    s_lshl_b32 s9, s73, 2
    s_add_u32 s9, s9, s74
    s_sub_u32 s9, s9, 4
    s_mul_i32 s9, s9, 384
    s_min_u32 s9, s9, L_codeend-L_pcref-384
    s_add_u32 s10, s10, s9
    s_addc_u32 s11, s11, 0
    v_lshlrev_b32 v25, 7, v1
    s_mov_b64 exec, 7
    global_load_dword v120, v25, s[10:11]
    s_mov_b64 exec, -1
    v_lshlrev_b32 v24, 4, v1
    v_add_u32 v24, 0x20000, v24
    v_mov_b32 v28, 0
    v_mov_b32 v29, 0
    v_mov_b32 v30, 0
    v_mov_b32 v31, 0
    ds_write_b128 v24, v[28:31]
    s_waitcnt lgkmcnt(0)
    s_mov_b64 s[48:49], s[16:17]
    buffer_load_dwordx4 v[112:115], v10, s[48:51], s100 offen nt
    buffer_load_dwordx4 v[116:119], v10, s[48:51], s100 offen offset:32 nt
    s_mov_b32 s52, s18
    s_mov_b32 s53, s19
    s_mov_b32 s54, 0x180000
    s_mov_b32 s55, 0x20000
    s_lshl_b32 s9, s2, 1
    s_add_u32 s9, s9, s14
    s_mul_i32 s9, s9, 3072
    s_lshl_b32 s8, s13, 10
    s_add_u32 s9, s9, s8
    s_mov_b64 exec, 0xff
    buffer_load_dword v121, v25, s[52:55], s9 offen offset:1024
    s_mov_b64 exec, -1
L_issued:
    s_load_dword s75, s[40:41], 0
    s_barrier
    s_mov_b32 s44, s40
    s_mov_b32 s45, s41
    s_mov_b32 s46, 0x1480000
    s_mov_b32 s47, 0x20000
    s_cmp_ge_u32 s74, 4
    s_cbranch_scc1 L_groupB
    s_and_b32 s7, s74, 1
    s_cmp_eq_u32 s7, 0
    s_cbranch_scc1 La0_1
    s_setprio 2
    s_lshl_b32 s5, s4, 13
    s_lshl_b32 s6, s3, 7
    s_add_u32 s5, s5, s6
    s_add_u32 s5, s5, 0x20000
    v_bfe_u32 v25, v1, 3, 1
    v_cmp_eq_u32 s[10:11], 1, v25
    v_lshl_add_u32 v25, v22, 3, v25
    v_lshrrev_b32 v26, 4, v1
    v_lshl_add_u32 v25, v26, 1, v25
    v_lshrrev_b32 v26, 4, v25
    v_and_b32 v25, 15, v25
    v_lshlrev_b32 v25, 3, v25
    v_lshl_add_u32 v25, v26, 11, v25
    v_mov_b32 v56, 0
    v_mov_b32 v57, 0
    v_mov_b32 v58, 0
    v_mov_b32 v59, 0
    v_mov_b32 v60, 0
    v_mov_b32 v61, 0
    v_mov_b32 v62, 0
    v_mov_b32 v63, 0
    s_waitcnt vmcnt(4)
    v_lshlrev_b32 v40, 16, v40
    v_lshlrev_b32 v41, 16, v41
    v_lshlrev_b32 v42, 16, v42
    v_lshlrev_b32 v43, 16, v43
    v_mul_f32 v48, 0xbfb8aa3b, v40
    v_mul_f32 v49, 0xbfb8aa3b, v41
    v_mul_f32 v50, 0xbfb8aa3b, v42
    v_mul_f32 v51, 0xbfb8aa3b, v43
    v_exp_f32 v48, v48
    v_exp_f32 v49, v49
    v_exp_f32 v50, v50
    v_exp_f32 v51, v51
    v_add_f32 v48, 1.0, v48
    v_add_f32 v49, 1.0, v49
    v_add_f32 v50, 1.0, v50
    v_add_f32 v51, 1.0, v51
    v_rcp_f32 v48, v48
    v_rcp_f32 v49, v49
    v_rcp_f32 v50, v50
    v_rcp_f32 v51, v51
    v_mul_f32 v40, v40, v48
    v_mul_f32 v41, v41, v49
    v_mul_f32 v42, v42, v50
    v_mul_f32 v43, v43, v51
    v_cvt_pk_bf16_f32 v48, v56, v40
    v_cvt_pk_bf16_f32 v40, v40, v56
    v_cvt_pk_bf16_f32 v49, v56, v41
    v_cvt_pk_bf16_f32 v41, v41, v56
    v_cvt_pk_bf16_f32 v50, v56, v42
    v_cvt_pk_bf16_f32 v42, v42, v56
    v_cvt_pk_bf16_f32 v51, v56, v43
    v_cvt_pk_bf16_f32 v43, v43, v56
    s_waitcnt vmcnt(3)
    v_dot2c_f32_bf16 v56, v40, v128
    v_dot2c_f32_bf16 v57, v48, v128
    v_dot2c_f32_bf16 v58, v40, v129
    v_dot2c_f32_bf16 v59, v48, v129
    v_dot2c_f32_bf16 v60, v40, v130
    v_dot2c_f32_bf16 v61, v48, v130
    v_dot2c_f32_bf16 v62, v40, v131
    v_dot2c_f32_bf16 v63, v48, v131
    s_waitcnt vmcnt(2)
    v_dot2c_f32_bf16 v56, v41, v132
    v_dot2c_f32_bf16 v57, v49, v132
    v_dot2c_f32_bf16 v58, v41, v133
    v_dot2c_f32_bf16 v59, v49, v133
    v_dot2c_f32_bf16 v60, v41, v134
    v_dot2c_f32_bf16 v61, v49, v134
    v_dot2c_f32_bf16 v62, v41, v135
    v_dot2c_f32_bf16 v63, v49, v135
    s_waitcnt vmcnt(1)
    v_dot2c_f32_bf16 v56, v42, v136
    v_dot2c_f32_bf16 v57, v50, v136
    v_dot2c_f32_bf16 v58, v42, v137
    v_dot2c_f32_bf16 v59, v50, v137
    v_dot2c_f32_bf16 v60, v42, v138
    v_dot2c_f32_bf16 v61, v50, v138
    v_dot2c_f32_bf16 v62, v42, v139
    v_dot2c_f32_bf16 v63, v50, v139
    s_waitcnt vmcnt(0)
    v_dot2c_f32_bf16 v56, v43, v140
    v_dot2c_f32_bf16 v57, v51, v140
    v_dot2c_f32_bf16 v58, v43, v141
    v_dot2c_f32_bf16 v59, v51, v141
    v_dot2c_f32_bf16 v60, v43, v142
    v_dot2c_f32_bf16 v61, v51, v142
    v_dot2c_f32_bf16 v62, v43, v143
    v_dot2c_f32_bf16 v63, v51, v143
    v_permlane32_swap_b32 v56, v60
    v_permlane32_swap_b32 v57, v61
    v_permlane32_swap_b32 v58, v62
    v_permlane32_swap_b32 v59, v63
    v_add_f32 v56, v56, v60
    v_add_f32 v57, v57, v61
    v_add_f32 v58, v58, v62
    v_add_f32 v59, v59, v63
    s_nop 0
    v_permlane16_swap_b32 v56, v58
    v_permlane16_swap_b32 v57, v59
    v_add_f32 v56, v56, v58
    v_add_f32 v57, v57, v59
    s_nop 0
    v_add_f32_dpp v56, v56, v56 row_ror:8 row_mask:0xf bank_mask:0xf
    v_add_f32_dpp v57, v57, v57 row_ror:8 row_mask:0xf bank_mask:0xf
    v_cndmask_b32 v56, v56, v57, s[10:11]
    s_cmp_eq_u32 s74, 3
    s_cbranch_scc1 La3_3
    s_waitcnt lgkmcnt(0)
    s_add_u32 s75, s75, 0x9e3779b9
    v_mov_b32 v57, s75
    buffer_store_dwordx2 v[56:57], v25, s[44:47], s5 offen sc1
    s_branch Lac_4
La0_1:
    s_setprio 2
    s_mov_b32 s84, 0x3f803f80
    s_getreg_b32 s78, hwreg(HW_REG_XCC_ID)
    v_mov_b32 v20, 0
    v_mov_b32 v21, 0
    v_mov_b32 v22, s78
    v_lshlrev_b32 v24, 1, v1
    s_lshr_b32 s3, s3, 6
    s_add_u32 s3, s3, 0x10000
    s_mov_b32 s10, 0x01010101
    s_mov_b32 s11, 0x01010101
    s_waitcnt vmcnt(7)
    v_dot2c_f32_bf16 v20, s84, v64
    v_dot2c_f32_bf16 v21, v64, v64
    v_dot2c_f32_bf16 v20, s84, v65
    v_dot2c_f32_bf16 v21, v65, v65
    v_dot2c_f32_bf16 v20, s84, v66
    v_dot2c_f32_bf16 v21, v66, v66
    v_dot2c_f32_bf16 v20, s84, v67
    v_dot2c_f32_bf16 v21, v67, v67
    s_waitcnt vmcnt(6)
    v_dot2c_f32_bf16 v20, s84, v68
    v_dot2c_f32_bf16 v21, v68, v68
    v_dot2c_f32_bf16 v20, s84, v69
    v_dot2c_f32_bf16 v21, v69, v69
    v_dot2c_f32_bf16 v20, s84, v70
    v_dot2c_f32_bf16 v21, v70, v70
    v_dot2c_f32_bf16 v20, s84, v71
    v_dot2c_f32_bf16 v21, v71, v71
    s_waitcnt vmcnt(5)
    v_dot2c_f32_bf16 v20, s84, v72
    v_dot2c_f32_bf16 v21, v72, v72
    v_dot2c_f32_bf16 v20, s84, v73
    v_dot2c_f32_bf16 v21, v73, v73
    v_dot2c_f32_bf16 v20, s84, v74
    v_dot2c_f32_bf16 v21, v74, v74
    v_dot2c_f32_bf16 v20, s84, v75
    v_dot2c_f32_bf16 v21, v75, v75
    s_waitcnt vmcnt(4)
    v_dot2c_f32_bf16 v20, s84, v76
    v_dot2c_f32_bf16 v21, v76, v76
    v_dot2c_f32_bf16 v20, s84, v77
    v_dot2c_f32_bf16 v21, v77, v77
    v_dot2c_f32_bf16 v20, s84, v78
    v_dot2c_f32_bf16 v21, v78, v78
    v_dot2c_f32_bf16 v20, s84, v79
    v_dot2c_f32_bf16 v21, v79, v79
    s_waitcnt vmcnt(3)
    v_dot2c_f32_bf16 v20, s84, v80
    v_dot2c_f32_bf16 v21, v80, v80
    v_dot2c_f32_bf16 v20, s84, v81
    v_dot2c_f32_bf16 v21, v81, v81
    v_dot2c_f32_bf16 v20, s84, v82
    v_dot2c_f32_bf16 v21, v82, v82
    v_dot2c_f32_bf16 v20, s84, v83
    v_dot2c_f32_bf16 v21, v83, v83
    s_waitcnt vmcnt(2)
    v_dot2c_f32_bf16 v20, s84, v84
    v_dot2c_f32_bf16 v21, v84, v84
    v_dot2c_f32_bf16 v20, s84, v85
    v_dot2c_f32_bf16 v21, v85, v85
    v_dot2c_f32_bf16 v20, s84, v86
    v_dot2c_f32_bf16 v21, v86, v86
    v_dot2c_f32_bf16 v20, s84, v87
    v_dot2c_f32_bf16 v21, v87, v87
    s_waitcnt vmcnt(1)
    v_dot2c_f32_bf16 v20, s84, v88
    v_dot2c_f32_bf16 v21, v88, v88
    v_dot2c_f32_bf16 v20, s84, v89
    v_dot2c_f32_bf16 v21, v89, v89
    v_dot2c_f32_bf16 v20, s84, v90
    v_dot2c_f32_bf16 v21, v90, v90
    v_dot2c_f32_bf16 v20, s84, v91
    v_dot2c_f32_bf16 v21, v91, v91
    s_waitcnt vmcnt(0)
    v_dot2c_f32_bf16 v20, s84, v92
    v_dot2c_f32_bf16 v21, v92, v92
    v_dot2c_f32_bf16 v20, s84, v93
    v_dot2c_f32_bf16 v21, v93, v93
    v_dot2c_f32_bf16 v20, s84, v94
    v_dot2c_f32_bf16 v21, v94, v94
    v_dot2c_f32_bf16 v20, s84, v95
    v_dot2c_f32_bf16 v21, v95, v95
    s_nop 1
    v_add_f32_dpp v20, v20, v20 quad_perm:[1,0,3,2] row_mask:0xf bank_mask:0xf
    v_add_f32_dpp v21, v21, v21 quad_perm:[1,0,3,2] row_mask:0xf bank_mask:0xf
    s_nop 0
    v_add_f32_dpp v20, v20, v20 quad_perm:[2,3,0,1] row_mask:0xf bank_mask:0xf
    v_add_f32_dpp v21, v21, v21 quad_perm:[2,3,0,1] row_mask:0xf bank_mask:0xf
    s_nop 0
    v_add_f32_dpp v20, v20, v20 row_half_mirror row_mask:0xf bank_mask:0xf
    v_add_f32_dpp v21, v21, v21 row_half_mirror row_mask:0xf bank_mask:0xf
    v_mul_f32 v20, 0.001953125, v20
    v_mul_f32 v21, 0.001953125, v21
    v_fma_f32 v21, -v20, v20, v21
    v_max_f32 v21, 0, v21
    v_add_f32 v21, 0x3727c5ac, v21
    v_rsq_f32 v21, v21
    s_cmp_eq_u32 s74, 2
    s_cbranch_scc1 La2_2
    s_waitcnt lgkmcnt(0)
    s_add_u32 s75, s75, 0x9e3779b9
    v_mov_b32 v23, s75
    s_mov_b64 exec, s[10:11]
    buffer_store_dwordx4 v[20:23], v24, s[44:47], s3 offen sc1
    s_mov_b64 exec, -1
    s_branch Lac_4
La2_2:
L_a2:
    s_setprio 0
    s_mov_b32 s52, s18
    s_mov_b32 s53, s19
    s_mov_b32 s54, 0x180000
    s_mov_b32 s55, 0x20000
    v_and_b32 v22, 15, v1
    v_lshlrev_b32 v22, 7, v22
    v_bfe_u32 v23, v1, 4, 1
    v_mul_u32_u24 v23, 3072, v23
    v_add_u32 v22, v22, v23
    s_mul_i32 s9, s2, 6144
    s_mov_b32 s56, s20
    s_mov_b32 s57, s21
    s_mov_b32 s58, 0x4000
    s_mov_b32 s59, 0x20000
    v_and_b32 v28, 15, v1
    v_lshlrev_b32 v28, 1, v28
    v_bfe_u32 v29, v1, 4, 1
    v_lshl_add_u32 v28, v29, 9, v28
    v_lshrrev_b32 v29, 5, v1
    v_lshl_add_u32 v28, v29, 7, v28
    s_and_b32 s8, s73, 15
    s_lshl_b32 s8, s8, 10
    buffer_load_ushort v32, v28, s[56:59], s8 offen offset:0
    buffer_load_ushort v33, v28, s[56:59], s8 offen offset:32
    buffer_load_ushort v34, v28, s[56:59], s8 offen offset:64
    buffer_load_ushort v35, v28, s[56:59], s8 offen offset:96
    buffer_load_ushort v36, v28, s[56:59], s8 offen offset:256
    buffer_load_ushort v37, v28, s[56:59], s8 offen offset:288
    buffer_load_ushort v38, v28, s[56:59], s8 offen offset:320
    buffer_load_ushort v39, v28, s[56:59], s8 offen offset:352
    v_and_b32 v22, 7, v1
    v_mul_u32_u24 v22, 1040, v22
    v_add_u32 v22, 0x24c00, v22
    v_mov_b32 v24, 0x3f803f80
    v_mov_b32 v25, 0x3f803f80
    v_mov_b32 v26, 0x3f803f80
    v_mov_b32 v27, 0x3f803f80
    ds_write_b128 v22, v[24:27]
    v_lshrrev_b32 v20, 3, v1
    v_mul_u32_u24 v21, 6144, v20
    v_and_b32 v22, 7, v1
    v_lshl_add_u32 v21, v22, 4, v21
    v_lshlrev_b32 v20, 1, v20
    s_mov_b32 s60, s34
    s_mov_b32 s61, s35
    s_mov_b32 s62, 0x300000
    s_mov_b32 s63, 0x20000
    s_mov_b32 s64, s32
    s_mov_b32 s65, s33
    s_mov_b32 s66, 0x400
    s_mov_b32 s67, 0x20000
    s_lshr_b32 s88, s2, 5
    s_and_b32 s89, s2, 31
    s_mul_i32 s9, s88, 393216
    s_lshl_b32 s8, s89, 7
    s_add_u32 s9, s9, s8
    s_add_u32 s9, s9, 2048
    s_lshl_b32 s88, s88, 7
    s_lshl_b32 s89, s89, 12
    s_add_u32 s89, s89, s88
    s_add_u32 s89, s89, 0x40000
    buffer_load_ushort v40, v20, s[64:67], s88 offen offset:0
    buffer_load_ushort v41, v20, s[64:67], s88 offen offset:16
    buffer_load_ushort v42, v20, s[64:67], s88 offen offset:32
    buffer_load_ushort v43, v20, s[64:67], s88 offen offset:48
    buffer_load_ushort v44, v20, s[64:67], s88 offen offset:64
    buffer_load_ushort v45, v20, s[64:67], s88 offen offset:80
    buffer_load_ushort v46, v20, s[64:67], s88 offen offset:96
    buffer_load_ushort v47, v20, s[64:67], s88 offen offset:112
    v_mov_b32 v8, 0x20000
    s_mov_b32 s77, 0x80000
    s_waitcnt lgkmcnt(0)
    s_add_u32 s75, s75, 0x9e3779b9
    v_lshlrev_b32 v2, 4, v1
    buffer_load_dwordx4 v[64:67], v21, s[60:63], s9 offen nt
    s_add_u32 s9, s9, 49152
    buffer_load_dwordx4 v[68:71], v21, s[60:63], s9 offen nt
    s_add_u32 s9, s9, 49152
    buffer_load_dwordx4 v[72:75], v21, s[60:63], s9 offen nt
    s_add_u32 s9, s9, 49152
    buffer_load_dwordx4 v[76:79], v21, s[60:63], s9 offen nt
    s_add_u32 s9, s9, 49152
    buffer_load_dwordx4 v[80:83], v21, s[60:63], s9 offen nt
    s_add_u32 s9, s9, 49152
    buffer_load_dwordx4 v[84:87], v21, s[60:63], s9 offen nt
    s_add_u32 s9, s9, 49152
    buffer_load_dwordx4 v[88:91], v21, s[60:63], s9 offen nt
    s_add_u32 s9, s9, 49152
    buffer_load_dwordx4 v[92:95], v21, s[60:63], s9 offen nt
    v_bfe_u32 v25, v1, 3, 1
    v_cmp_eq_u32 s[10:11], 1, v25
    v_lshl_add_u32 v25, v22, 3, v25
    v_lshrrev_b32 v26, 4, v1
    v_lshl_add_u32 v25, v26, 1, v25
    v_lshrrev_b32 v26, 4, v25
    v_and_b32 v25, 15, v25
    v_lshlrev_b32 v25, 3, v25
    v_lshl_add_u32 v25, v26, 10, v25
    v_mov_b32 v56, 0
    v_mov_b32 v57, 0
    v_mov_b32 v58, 0
    v_mov_b32 v59, 0
    v_mov_b32 v60, 0
    v_mov_b32 v61, 0
    v_mov_b32 v62, 0
    v_mov_b32 v63, 0
    s_waitcnt vmcnt(8)
    v_lshlrev_b32 v40, 16, v40
    v_lshlrev_b32 v41, 16, v41
    v_lshlrev_b32 v42, 16, v42
    v_lshlrev_b32 v43, 16, v43
    v_lshlrev_b32 v44, 16, v44
    v_lshlrev_b32 v45, 16, v45
    v_lshlrev_b32 v46, 16, v46
    v_lshlrev_b32 v47, 16, v47
    v_mul_f32 v48, 0xbfb8aa3b, v40
    v_mul_f32 v49, 0xbfb8aa3b, v41
    v_mul_f32 v50, 0xbfb8aa3b, v42
    v_mul_f32 v51, 0xbfb8aa3b, v43
    v_mul_f32 v52, 0xbfb8aa3b, v44
    v_mul_f32 v53, 0xbfb8aa3b, v45
    v_mul_f32 v54, 0xbfb8aa3b, v46
    v_mul_f32 v55, 0xbfb8aa3b, v47
    v_exp_f32 v48, v48
    v_exp_f32 v49, v49
    v_exp_f32 v50, v50
    v_exp_f32 v51, v51
    v_exp_f32 v52, v52
    v_exp_f32 v53, v53
    v_exp_f32 v54, v54
    v_exp_f32 v55, v55
    v_add_f32 v48, 1.0, v48
    v_add_f32 v49, 1.0, v49
    v_add_f32 v50, 1.0, v50
    v_add_f32 v51, 1.0, v51
    v_add_f32 v52, 1.0, v52
    v_add_f32 v53, 1.0, v53
    v_add_f32 v54, 1.0, v54
    v_add_f32 v55, 1.0, v55
    v_rcp_f32 v48, v48
    v_rcp_f32 v49, v49
    v_rcp_f32 v50, v50
    v_rcp_f32 v51, v51
    v_rcp_f32 v52, v52
    v_rcp_f32 v53, v53
    v_rcp_f32 v54, v54
    v_rcp_f32 v55, v55
    v_mul_f32 v40, v40, v48
    v_mul_f32 v41, v41, v49
    v_mul_f32 v42, v42, v50
    v_mul_f32 v43, v43, v51
    v_mul_f32 v44, v44, v52
    v_mul_f32 v45, v45, v53
    v_mul_f32 v46, v46, v54
    v_mul_f32 v47, v47, v55
    v_cvt_pk_bf16_f32 v48, v56, v40
    v_cvt_pk_bf16_f32 v40, v40, v56
    v_cvt_pk_bf16_f32 v49, v56, v41
    v_cvt_pk_bf16_f32 v41, v41, v56
    v_cvt_pk_bf16_f32 v50, v56, v42
    v_cvt_pk_bf16_f32 v42, v42, v56
    v_cvt_pk_bf16_f32 v51, v56, v43
    v_cvt_pk_bf16_f32 v43, v43, v56
    v_cvt_pk_bf16_f32 v52, v56, v44
    v_cvt_pk_bf16_f32 v44, v44, v56
    v_cvt_pk_bf16_f32 v53, v56, v45
    v_cvt_pk_bf16_f32 v45, v45, v56
    v_cvt_pk_bf16_f32 v54, v56, v46
    v_cvt_pk_bf16_f32 v46, v46, v56
    v_cvt_pk_bf16_f32 v55, v56, v47
    v_cvt_pk_bf16_f32 v47, v47, v56
    s_waitcnt vmcnt(7)
    v_dot2c_f32_bf16 v56, v40, v64
    v_dot2c_f32_bf16 v57, v48, v64
    v_dot2c_f32_bf16 v58, v40, v65
    v_dot2c_f32_bf16 v59, v48, v65
    v_dot2c_f32_bf16 v60, v40, v66
    v_dot2c_f32_bf16 v61, v48, v66
    v_dot2c_f32_bf16 v62, v40, v67
    v_dot2c_f32_bf16 v63, v48, v67
    s_waitcnt vmcnt(6)
    v_dot2c_f32_bf16 v56, v41, v68
    v_dot2c_f32_bf16 v57, v49, v68
    v_dot2c_f32_bf16 v58, v41, v69
    v_dot2c_f32_bf16 v59, v49, v69
    v_dot2c_f32_bf16 v60, v41, v70
    v_dot2c_f32_bf16 v61, v49, v70
    v_dot2c_f32_bf16 v62, v41, v71
    v_dot2c_f32_bf16 v63, v49, v71
    s_waitcnt vmcnt(5)
    v_dot2c_f32_bf16 v56, v42, v72
    v_dot2c_f32_bf16 v57, v50, v72
    v_dot2c_f32_bf16 v58, v42, v73
    v_dot2c_f32_bf16 v59, v50, v73
    v_dot2c_f32_bf16 v60, v42, v74
    v_dot2c_f32_bf16 v61, v50, v74
    v_dot2c_f32_bf16 v62, v42, v75
    v_dot2c_f32_bf16 v63, v50, v75
    s_waitcnt vmcnt(4)
    v_dot2c_f32_bf16 v56, v43, v76
    v_dot2c_f32_bf16 v57, v51, v76
    v_dot2c_f32_bf16 v58, v43, v77
    v_dot2c_f32_bf16 v59, v51, v77
    v_dot2c_f32_bf16 v60, v43, v78
    v_dot2c_f32_bf16 v61, v51, v78
    v_dot2c_f32_bf16 v62, v43, v79
    v_dot2c_f32_bf16 v63, v51, v79
    s_waitcnt vmcnt(3)
    v_dot2c_f32_bf16 v56, v44, v80
    v_dot2c_f32_bf16 v57, v52, v80
    v_dot2c_f32_bf16 v58, v44, v81
    v_dot2c_f32_bf16 v59, v52, v81
    v_dot2c_f32_bf16 v60, v44, v82
    v_dot2c_f32_bf16 v61, v52, v82
    v_dot2c_f32_bf16 v62, v44, v83
    v_dot2c_f32_bf16 v63, v52, v83
    s_waitcnt vmcnt(2)
    v_dot2c_f32_bf16 v56, v45, v84
    v_dot2c_f32_bf16 v57, v53, v84
    v_dot2c_f32_bf16 v58, v45, v85
    v_dot2c_f32_bf16 v59, v53, v85
    v_dot2c_f32_bf16 v60, v45, v86
    v_dot2c_f32_bf16 v61, v53, v86
    v_dot2c_f32_bf16 v62, v45, v87
    v_dot2c_f32_bf16 v63, v53, v87
    s_waitcnt vmcnt(1)
    v_dot2c_f32_bf16 v56, v46, v88
    v_dot2c_f32_bf16 v57, v54, v88
    v_dot2c_f32_bf16 v58, v46, v89
    v_dot2c_f32_bf16 v59, v54, v89
    v_dot2c_f32_bf16 v60, v46, v90
    v_dot2c_f32_bf16 v61, v54, v90
    v_dot2c_f32_bf16 v62, v46, v91
    v_dot2c_f32_bf16 v63, v54, v91
    s_waitcnt vmcnt(0)
    v_dot2c_f32_bf16 v56, v47, v92
    v_dot2c_f32_bf16 v57, v55, v92
    v_dot2c_f32_bf16 v58, v47, v93
    v_dot2c_f32_bf16 v59, v55, v93
    v_dot2c_f32_bf16 v60, v47, v94
    v_dot2c_f32_bf16 v61, v55, v94
    v_dot2c_f32_bf16 v62, v47, v95
    v_dot2c_f32_bf16 v63, v55, v95
    v_permlane32_swap_b32 v56, v60
    v_permlane32_swap_b32 v57, v61
    v_permlane32_swap_b32 v58, v62
    v_permlane32_swap_b32 v59, v63
    v_add_f32 v56, v56, v60
    v_add_f32 v57, v57, v61
    v_add_f32 v58, v58, v62
    v_add_f32 v59, v59, v63
    s_nop 0
    v_permlane16_swap_b32 v56, v58
    v_permlane16_swap_b32 v57, v59
    v_add_f32 v56, v56, v58
    v_add_f32 v57, v57, v59
    s_nop 0
    v_add_f32_dpp v56, v56, v56 row_ror:8 row_mask:0xf bank_mask:0xf
    v_add_f32_dpp v57, v57, v57 row_ror:8 row_mask:0xf bank_mask:0xf
    v_cndmask_b32 v56, v56, v57, s[10:11]
    v_mov_b32 v57, s75
    buffer_store_dwordx2 v[56:57], v25, s[44:47], s89 offen sc1
    s_branch Lad_5
La3_3:
    s_setprio 0
    v_lshlrev_b32 v2, 4, v1
    v_mov_b32 v8, 0x20000
    s_mov_b32 s77, 0x80000
Lev_6:
    ds_read_b32 v27, v8 offset:592
    s_waitcnt lgkmcnt(0)
    v_cmp_ne_u32 vcc, 0x0101, v27
    s_cbranch_vccz Levd_7
    s_sleep 1
    s_sub_u32 s77, s77, 1
    s_cbranch_scc1 L_end
    s_branch Lev_6
Levd_7:
    s_add_u32 s75, s75, 0x9e3779b9
    s_mov_b32 s56, s20
    s_mov_b32 s57, s21
    s_mov_b32 s58, 0x4000
    s_mov_b32 s59, 0x20000
    v_and_b32 v28, 15, v1
    v_lshlrev_b32 v28, 1, v28
    v_bfe_u32 v29, v1, 4, 1
    v_lshl_add_u32 v28, v29, 9, v28
    v_lshrrev_b32 v29, 5, v1
    v_lshl_add_u32 v28, v29, 7, v28
    s_and_b32 s8, s73, 15
    s_lshl_b32 s8, s8, 10
    buffer_load_ushort v32, v28, s[56:59], s8 offen offset:0
    buffer_load_ushort v33, v28, s[56:59], s8 offen offset:32
    buffer_load_ushort v34, v28, s[56:59], s8 offen offset:64
    buffer_load_ushort v35, v28, s[56:59], s8 offen offset:96
    buffer_load_ushort v36, v28, s[56:59], s8 offen offset:256
    buffer_load_ushort v37, v28, s[56:59], s8 offen offset:288
    buffer_load_ushort v38, v28, s[56:59], s8 offen offset:320
    buffer_load_ushort v39, v28, s[56:59], s8 offen offset:352
    s_mul_i32 s88, s2, 6144
    s_add_u32 s90, s18, s88
    s_addc_u32 s91, s19, 0
    s_load_dword s92, s[90:91], 0
    s_load_dword s93, s[90:91], 64
    s_load_dword s94, s[90:91], 128
    s_load_dword s95, s[90:91], 192
    s_load_dword s92, s[90:91], 256
    s_load_dword s93, s[90:91], 320
    s_load_dword s94, s[90:91], 384
    s_load_dword s95, s[90:91], 448
    s_load_dword s92, s[90:91], 512
    s_load_dword s93, s[90:91], 576
    s_load_dword s94, s[90:91], 640
    s_load_dword s95, s[90:91], 704
    s_load_dword s92, s[90:91], 768
    s_load_dword s93, s[90:91], 832
    s_load_dword s94, s[90:91], 896
    s_load_dword s95, s[90:91], 960
    s_load_dword s92, s[90:91], 3072
    s_load_dword s93, s[90:91], 3136
    s_load_dword s94, s[90:91], 3200
    s_load_dword s95, s[90:91], 3264
    s_load_dword s92, s[90:91], 3328
    s_load_dword s93, s[90:91], 3392
    s_load_dword s94, s[90:91], 3456
    s_load_dword s95, s[90:91], 3520
    s_load_dword s92, s[90:91], 3584
    s_load_dword s93, s[90:91], 3648
    s_load_dword s94, s[90:91], 3712
    s_load_dword s95, s[90:91], 3776
    s_load_dword s92, s[90:91], 3840
    s_load_dword s93, s[90:91], 3904
    s_load_dword s94, s[90:91], 3968
    s_load_dword s95, s[90:91], 4032
    s_branch Lad_5
Lac_4:
    v_mov_b32 v8, 0x20000
    v_add_u32 v7, s74, v8
    v_mov_b32 v9, 1
    ds_write_b8 v7, v9 offset:592
    s_setprio 0
    v_lshlrev_b32 v2, 4, v1
    s_mov_b32 s77, 0x80000
    s_mov_b32 s52, s18
    s_mov_b32 s53, s19
    s_mov_b32 s54, 0x180000
    s_mov_b32 s55, 0x20000
    v_lshrrev_b32 v28, 2, v1
    v_mul_u32_u24 v28, 3072, v28
    v_and_b32 v10, 3, v1
    v_lshl_add_u32 v10, v10, 4, v28
    s_lshr_b32 s3, s73, 3
    s_and_b32 s3, s3, 2
    s_and_b32 s4, s73, 1
    s_add_u32 s7, s3, s4
    s_and_b32 s6, s73, 15
    s_lshl_b32 s6, s6, 6
    s_lshl_b32 s9, s74, 16
    s_lshl_b32 s4, s74, 10
    s_add_u32 s6, s6, s4
    s_add_u32 s6, s6, 1024
    s_add_u32 s3, s6, s18
    s_bfe_u32 s3, s3, 0x30007
    s_cmp_eq_u32 s3, 3
    s_cselect_b32 s7, s7, 0
Lev_8:
    ds_read_b32 v27, v8 offset:592
    s_waitcnt lgkmcnt(0)
    v_cmp_ne_u32 vcc, 0x0101, v27
    s_cbranch_vccz Levd_9
    s_sleep 1
    s_sub_u32 s77, s77, 1
    s_cbranch_scc1 L_end
    s_branch Lev_8
Levd_9:
    s_mul_i32 s3, s7, 393216
    s_add_u32 s3, s3, s6
    s_lshl_b32 s4, s7, 13
    s_add_u32 s4, s4, s9
    s_add_u32 m0, s4, 0
    s_nop 0
    buffer_load_dwordx4 v10, s[52:55], s3 offen lds
    s_add_u32 s3, s3, 49152
    s_add_u32 m0, s4, 1024
    s_nop 0
    buffer_load_dwordx4 v10, s[52:55], s3 offen lds
    s_add_u32 s3, s3, 49152
    s_add_u32 m0, s4, 2048
    s_nop 0
    buffer_load_dwordx4 v10, s[52:55], s3 offen lds
    s_add_u32 s3, s3, 49152
    s_add_u32 m0, s4, 3072
    s_nop 0
    buffer_load_dwordx4 v10, s[52:55], s3 offen lds
    s_add_u32 s3, s3, 49152
    s_add_u32 m0, s4, 4096
    s_nop 0
    buffer_load_dwordx4 v10, s[52:55], s3 offen lds
    s_add_u32 s3, s3, 49152
    s_add_u32 m0, s4, 5120
    s_nop 0
    buffer_load_dwordx4 v10, s[52:55], s3 offen lds
    s_add_u32 s3, s3, 49152
    s_add_u32 m0, s4, 6144
    s_nop 0
    buffer_load_dwordx4 v10, s[52:55], s3 offen lds
    s_add_u32 s3, s3, 49152
    s_add_u32 m0, s4, 7168
    s_nop 0
    buffer_load_dwordx4 v10, s[52:55], s3 offen lds
    s_add_u32 s7, s7, 1
    s_and_b32 s7, s7, 3
    s_mul_i32 s3, s7, 393216
    s_add_u32 s3, s3, s6
    s_lshl_b32 s4, s7, 13
    s_add_u32 s4, s4, s9
    s_add_u32 m0, s4, 0
    s_waitcnt vmcnt(7)
    buffer_load_dwordx4 v10, s[52:55], s3 offen lds
    s_add_u32 s3, s3, 49152
    s_add_u32 m0, s4, 1024
    s_waitcnt vmcnt(7)
    buffer_load_dwordx4 v10, s[52:55], s3 offen lds
    s_add_u32 s3, s3, 49152
    s_add_u32 m0, s4, 2048
    s_waitcnt vmcnt(7)
    buffer_load_dwordx4 v10, s[52:55], s3 offen lds
    s_add_u32 s3, s3, 49152
    s_add_u32 m0, s4, 3072
    s_waitcnt vmcnt(7)
    buffer_load_dwordx4 v10, s[52:55], s3 offen lds
    s_add_u32 s3, s3, 49152
    s_add_u32 m0, s4, 4096
    s_waitcnt vmcnt(7)
    buffer_load_dwordx4 v10, s[52:55], s3 offen lds
    s_add_u32 s3, s3, 49152
    s_add_u32 m0, s4, 5120
    s_waitcnt vmcnt(7)
    buffer_load_dwordx4 v10, s[52:55], s3 offen lds
    s_add_u32 s3, s3, 49152
    s_add_u32 m0, s4, 6144
    s_waitcnt vmcnt(7)
    buffer_load_dwordx4 v10, s[52:55], s3 offen lds
    s_add_u32 s3, s3, 49152
    s_add_u32 m0, s4, 7168
    s_waitcnt vmcnt(7)
    buffer_load_dwordx4 v10, s[52:55], s3 offen lds
    s_add_u32 s7, s7, 1
    s_and_b32 s7, s7, 3
    s_mul_i32 s3, s7, 393216
    s_add_u32 s3, s3, s6
    s_lshl_b32 s4, s7, 13
    s_add_u32 s4, s4, s9
    s_add_u32 m0, s4, 0
    s_waitcnt vmcnt(7)
    buffer_load_dwordx4 v10, s[52:55], s3 offen lds
    s_add_u32 s3, s3, 49152
    s_add_u32 m0, s4, 1024
    s_waitcnt vmcnt(7)
    buffer_load_dwordx4 v10, s[52:55], s3 offen lds
    s_add_u32 s3, s3, 49152
    s_add_u32 m0, s4, 2048
    s_waitcnt vmcnt(7)
    buffer_load_dwordx4 v10, s[52:55], s3 offen lds
    s_add_u32 s3, s3, 49152
    s_add_u32 m0, s4, 3072
    s_waitcnt vmcnt(7)
    buffer_load_dwordx4 v10, s[52:55], s3 offen lds
    s_add_u32 s3, s3, 49152
    s_add_u32 m0, s4, 4096
    s_waitcnt vmcnt(7)
    buffer_load_dwordx4 v10, s[52:55], s3 offen lds
    s_add_u32 s3, s3, 49152
    s_add_u32 m0, s4, 5120
    s_waitcnt vmcnt(7)
    buffer_load_dwordx4 v10, s[52:55], s3 offen lds
    s_add_u32 s3, s3, 49152
    s_add_u32 m0, s4, 6144
    s_waitcnt vmcnt(7)
    buffer_load_dwordx4 v10, s[52:55], s3 offen lds
    s_add_u32 s3, s3, 49152
    s_add_u32 m0, s4, 7168
    s_waitcnt vmcnt(7)
    buffer_load_dwordx4 v10, s[52:55], s3 offen lds
    s_add_u32 s7, s7, 1
    s_and_b32 s7, s7, 3
    s_mul_i32 s3, s7, 393216
    s_add_u32 s3, s3, s6
    s_lshl_b32 s4, s7, 13
    s_add_u32 s4, s4, s9
    s_add_u32 m0, s4, 0
    s_waitcnt vmcnt(7)
    buffer_load_dwordx4 v10, s[52:55], s3 offen lds
    s_add_u32 s3, s3, 49152
    s_add_u32 m0, s4, 1024
    s_waitcnt vmcnt(7)
    buffer_load_dwordx4 v10, s[52:55], s3 offen lds
    s_add_u32 s3, s3, 49152
    s_add_u32 m0, s4, 2048
    s_waitcnt vmcnt(7)
    buffer_load_dwordx4 v10, s[52:55], s3 offen lds
    s_add_u32 s3, s3, 49152
    s_add_u32 m0, s4, 3072
    s_waitcnt vmcnt(7)
    buffer_load_dwordx4 v10, s[52:55], s3 offen lds
    s_add_u32 s3, s3, 49152
    s_add_u32 m0, s4, 4096
    s_waitcnt vmcnt(7)
    buffer_load_dwordx4 v10, s[52:55], s3 offen lds
    s_add_u32 s3, s3, 49152
    s_add_u32 m0, s4, 5120
    s_waitcnt vmcnt(7)
    buffer_load_dwordx4 v10, s[52:55], s3 offen lds
    s_add_u32 s3, s3, 49152
    s_add_u32 m0, s4, 6144
    s_waitcnt vmcnt(7)
    buffer_load_dwordx4 v10, s[52:55], s3 offen lds
    s_add_u32 s3, s3, 49152
    s_add_u32 m0, s4, 7168
    s_waitcnt vmcnt(7)
    buffer_load_dwordx4 v10, s[52:55], s3 offen lds
    s_mov_b32 s56, s20
    s_mov_b32 s57, s21
    s_mov_b32 s58, 0x4000
    s_mov_b32 s59, 0x20000
    v_and_b32 v28, 15, v1
    v_lshlrev_b32 v28, 1, v28
    v_bfe_u32 v29, v1, 4, 1
    v_lshl_add_u32 v28, v29, 9, v28
    v_lshrrev_b32 v29, 5, v1
    v_lshl_add_u32 v28, v29, 7, v28
    s_and_b32 s8, s73, 15
    s_lshl_b32 s8, s8, 10
    buffer_load_ushort v32, v28, s[56:59], s8 offen offset:0
    buffer_load_ushort v33, v28, s[56:59], s8 offen offset:32
    buffer_load_ushort v34, v28, s[56:59], s8 offen offset:64
    buffer_load_ushort v35, v28, s[56:59], s8 offen offset:96
    buffer_load_ushort v36, v28, s[56:59], s8 offen offset:256
    buffer_load_ushort v37, v28, s[56:59], s8 offen offset:288
    buffer_load_ushort v38, v28, s[56:59], s8 offen offset:320
    buffer_load_ushort v39, v28, s[56:59], s8 offen offset:352
Lad_5:
    v_mov_b32 v8, 0x20000
    v_add_u32 v7, s74, v8
    v_mov_b32 v9, 1
    s_mov_b32 s77, 0x80000
    s_mov_b32 s80, 0x3fb8aa3b
    s_mov_b32 s81, 0x3fb8aa3b
    v_bfe_u32 v20, v1, 2, 2
    v_lshlrev_b32 v20, 6, v20
    v_and_b32 v21, 3, v1
    v_lshl_add_u32 v20, v21, 3, v20
    v_bfe_u32 v21, v1, 4, 1
    v_lshl_add_u32 v20, v21, 5, v20
    v_lshrrev_b32 v21, 5, v1
    v_lshl_add_u32 v3, v21, 8, v20
    v_lshl_add_u32 v4, v21, 9, v20
    v_add_u32 v5, 0x10000, v3
    v_add_u32 v6, 0x10000, v4
    s_lshr_b32 s13, s73, 4
    s_and_b32 s15, s73, 15
    s_lshl_b32 s14, s13, 2
    s_add_u32 s14, s14, s74
    s_lshl_b32 s12, s72, 3
    s_add_u32 s12, s12, s14
    v_and_b32 v20, 31, v1
    v_bfe_u32 v21, v1, 1, 3
    v_lshrrev_b32 v22, 5, v1
    v_xor_b32 v21, v21, v22
    v_lshlrev_b32 v21, 3, v21
    v_lshl_add_u32 v20, v20, 6, v21
    s_lshl_b32 s3, s74, 11
    s_add_u32 s3, s3, 0x20800
    v_add_u32 v24, s3, v20
    v_xor_b32 v25, 16, v24
    v_xor_b32 v26, 32, v24
    v_xor_b32 v27, 48, v24
    s_mul_i32 s3, s74, 2080
    s_add_u32 s3, s3, 0x24800
    v_add_u32 v28, s3, v2
    v_bfe_u32 v20, v1, 3, 1
    v_lshl_add_u32 v20, v22, 1, v20
    v_lshlrev_b32 v20, 3, v20
    v_xor_b32 v20, v20, v3
    s_lshl_b32 s3, s74, 13
    s_add_u32 s3, s3, 0x20800
    v_add_u32 v29, s3, v20
    v_xor_b32 v30, 32, v29
    v_bfe_u32 v20, v1, 4, 1
    v_cmp_eq_u32 s[60:61], s74, v20
    v_mov_b32 v20, 1024
    s_nop 0
    v_cndmask_b32 v20, v20, v2, s[60:61]
    v_add_u32 v31, 0x24800, v20
    s_lshl_b32 s4, s72, 1
    s_add_u32 s4, s4, s13
    s_lshl_b32 s5, s4, 10
    s_mul_i32 s3, s15, 52992
    s_add_u32 s3, s3, s5
    s_add_u32 s68, s3, 0x100000
    s_lshl_b32 s5, s15, 4
    s_add_u32 s5, s5, s4
    s_lshl_b32 s5, s5, 1
    s_add_u32 s5, s5, s74
    s_lshl_b32 s5, s5, 7
    s_add_u32 s69, s5, 0x1e0000
    v_and_b32 v20, 3, v1
    v_lshlrev_b32 v22, 2, v22
    v_add_lshl_u32 v10, v22, v20, 4
    v_cmp_eq_u32 s[62:63], 0, v20
    v_cmp_eq_u32 s[64:65], 1, v20
    s_mov_b32 s66, 0x000f000f
    s_mov_b32 s67, 0x000f000f
    s_andn2_b64 s[66:67], s[66:67], s[60:61]
    s_lshl_b32 s3, s12, 15
    s_lshl_b32 s4, s15, 11
    s_add_u32 s3, s3, s4
    s_add_u32 s70, s3, 0x400000
    s_lshl_b32 s4, s12, 7
    s_lshl_b32 s5, s15, 2
    s_add_u32 s4, s4, s5
    s_add_u32 s71, s4, 0x2000
    v_and_b32 v11, 15, v1
    v_lshlrev_b32 v11, 2, v11
    v_lshrrev_b32 v20, 4, v1
    v_lshl_add_u32 v11, v20, 7, v11
    s_lshl_b32 s3, s12, 7
    s_add_u32 s3, s3, 0xc000
    s_lshl_b32 s4, s12, 15
    s_add_u32 s4, s4, 0x200000
    s_waitcnt vmcnt(0)
    ds_write_b8 v7, v9 offset:0
    v_and_b32 v20, 16, v1
    v_cmp_eq_u32 vcc, 0, v20
    v_lshl_or_b32 v32, v33, 16, v32
    v_lshl_or_b32 v34, v35, 16, v34
    v_lshl_or_b32 v36, v37, 16, v36
    v_lshl_or_b32 v38, v39, 16, v38
    v_mov_b32 v21, 0
    v_cndmask_b32 v12, v21, v32, vcc
    v_cndmask_b32 v16, v32, v21, vcc
    v_cndmask_b32 v13, v21, v34, vcc
    v_cndmask_b32 v17, v34, v21, vcc
    v_cndmask_b32 v14, v21, v36, vcc
    v_cndmask_b32 v18, v36, v21, vcc
    v_cndmask_b32 v15, v21, v38, vcc
    v_cndmask_b32 v19, v38, v21, vcc
    s_cmp_lg_u32 s74, 0
    s_cbranch_scc1 Lgp_10
    buffer_load_dword v22, v11, s[44:47], s3 offen sc1
    s_sleep 2
Lpf_12:
    buffer_load_dword v23, v11, s[44:47], s3 offen sc1
    s_waitcnt vmcnt(1)
    v_cmp_ne_u32 vcc, s75, v22
    s_cbranch_vccz Lpfd_13
    buffer_load_dword v22, v11, s[44:47], s3 offen sc1
    s_waitcnt vmcnt(1)
    v_cmp_ne_u32 vcc, s75, v23
    s_cbranch_vccz Lpfd_13
    s_sub_u32 s77, s77, 1
    s_cbranch_scc1 L_end
    s_branch Lpf_12
Lpfd_13:
    ds_write_b8 v8, v9 offset:544
    s_branch Lgpd_11
Lgp_10:
Lev_14:
    ds_read_u8 v20, v8 offset:544
    s_waitcnt lgkmcnt(0)
    v_cmp_eq_u32 vcc, 0, v20
    s_cbranch_vccz Levd_15
    s_sub_u32 s77, s77, 1
    s_cbranch_scc1 L_end
    s_branch Lev_14
Levd_15:
Lgpd_11:
    s_setprio 2
    buffer_load_dwordx4 v[128:131], v2, s[44:47], s4 offen offset:0 sc1
    buffer_load_dwordx4 v[132:135], v2, s[44:47], s4 offen offset:1024 sc1
    buffer_load_dwordx4 v[136:139], v2, s[44:47], s4 offen offset:2048 sc1
    buffer_load_dwordx4 v[140:143], v2, s[44:47], s4 offen offset:3072 sc1
    s_add_u32 s4, s4, 4096
    buffer_load_dwordx4 v[144:147], v2, s[44:47], s4 offen offset:0 sc1
    buffer_load_dwordx4 v[148:151], v2, s[44:47], s4 offen offset:1024 sc1
    buffer_load_dwordx4 v[152:155], v2, s[44:47], s4 offen offset:2048 sc1
    buffer_load_dwordx4 v[156:159], v2, s[44:47], s4 offen offset:3072 sc1
Lev_16:
    ds_read_b32 v20, v8 offset:0
    s_waitcnt lgkmcnt(0)
    v_readfirstlane_b32 s98, v20
    s_nop 0
    s_cmp_eq_u32 s98, 0x01010101
    s_cbranch_scc1 Levd_17
    s_sub_u32 s77, s77, 1
    s_cbranch_scc1 L_end
    s_branch Lev_16
Levd_17:
    ds_read_b32 v20, v8 offset:240
    ds_read_b64_tr_b16 v[32:33], v4 offset:0
    ds_read_b64_tr_b16 v[34:35], v4 offset:256
    ds_read_b64_tr_b16 v[36:37], v6 offset:0
    ds_read_b64_tr_b16 v[38:39], v6 offset:256
    ds_read_b64_tr_b16 v[40:41], v4 offset:1024
    ds_read_b64_tr_b16 v[42:43], v4 offset:1280
    ds_read_b64_tr_b16 v[44:45], v6 offset:1024
    ds_read_b64_tr_b16 v[46:47], v6 offset:1280
    ds_read_b64_tr_b16 v[48:49], v4 offset:2048
    ds_read_b64_tr_b16 v[50:51], v4 offset:2304
    ds_read_b64_tr_b16 v[52:53], v6 offset:2048
    ds_read_b64_tr_b16 v[54:55], v6 offset:2304
    s_waitcnt vmcnt(7)
    s_waitcnt lgkmcnt(10)
    v_mfma_f32_32x32x16_bf16 v[64:79], v[32:35], v[128:131], 0
    ds_read_b64_tr_b16 v[56:57], v4 offset:3072
    ds_read_b64_tr_b16 v[58:59], v4 offset:3328
    s_add_u32 s4, s4, 4096
    buffer_load_dwordx4 v[160:163], v2, s[44:47], s4 offen offset:0 sc1
    v_readfirstlane_b32 s76, v20
    s_nop 0
    s_and_b32 s76, s76, 0x02020202
    s_waitcnt lgkmcnt(10)
    v_mfma_f32_32x32x16_bf16 v[80:95], v[128:131], v[36:39], 0
    ds_read_b64_tr_b16 v[60:61], v6 offset:3072
    ds_read_b64_tr_b16 v[62:63], v6 offset:3328
    s_waitcnt vmcnt(7)
    s_waitcnt lgkmcnt(10)
    v_mfma_f32_32x32x16_bf16 v[64:79], v[40:43], v[132:135], v[64:79]
    ds_read_b64_tr_b16 v[32:33], v4 offset:4096
    ds_read_b64_tr_b16 v[34:35], v4 offset:4352
    buffer_load_dwordx4 v[164:167], v2, s[44:47], s4 offen offset:1024 sc1
    s_waitcnt lgkmcnt(10)
    v_mfma_f32_32x32x16_bf16 v[80:95], v[132:135], v[44:47], v[80:95]
    ds_read_b64_tr_b16 v[36:37], v6 offset:4096
    ds_read_b64_tr_b16 v[38:39], v6 offset:4352
    s_waitcnt vmcnt(7)
    s_waitcnt lgkmcnt(10)
    v_mfma_f32_32x32x16_bf16 v[64:79], v[48:51], v[136:139], v[64:79]
    ds_read_b64_tr_b16 v[40:41], v4 offset:5120
    ds_read_b64_tr_b16 v[42:43], v4 offset:5376
    buffer_load_dwordx4 v[168:171], v2, s[44:47], s4 offen offset:2048 sc1
    s_waitcnt lgkmcnt(10)
    v_mfma_f32_32x32x16_bf16 v[80:95], v[136:139], v[52:55], v[80:95]
    ds_read_b64_tr_b16 v[44:45], v6 offset:5120
    ds_read_b64_tr_b16 v[46:47], v6 offset:5376
    s_waitcnt vmcnt(7)
    s_waitcnt lgkmcnt(10)
    v_mfma_f32_32x32x16_bf16 v[64:79], v[56:59], v[140:143], v[64:79]
    ds_read_b64_tr_b16 v[48:49], v4 offset:6144
    ds_read_b64_tr_b16 v[50:51], v4 offset:6400
    buffer_load_dwordx4 v[172:175], v2, s[44:47], s4 offen offset:3072 sc1
    s_waitcnt lgkmcnt(10)
    v_mfma_f32_32x32x16_bf16 v[80:95], v[140:143], v[60:63], v[80:95]
    ds_read_b64_tr_b16 v[52:53], v6 offset:6144
    ds_read_b64_tr_b16 v[54:55], v6 offset:6400
    s_waitcnt vmcnt(7)
    s_waitcnt lgkmcnt(10)
    v_mfma_f32_32x32x16_bf16 v[64:79], v[32:35], v[144:147], v[64:79]
    ds_read_b64_tr_b16 v[56:57], v4 offset:7168
    ds_read_b64_tr_b16 v[58:59], v4 offset:7424
    s_add_u32 s4, s4, 4096
    buffer_load_dwordx4 v[176:179], v2, s[44:47], s4 offen offset:0 sc1
    s_waitcnt lgkmcnt(10)
    v_mfma_f32_32x32x16_bf16 v[80:95], v[144:147], v[36:39], v[80:95]
    ds_read_b64_tr_b16 v[60:61], v6 offset:7168
    ds_read_b64_tr_b16 v[62:63], v6 offset:7424
    s_waitcnt vmcnt(7)
    s_waitcnt lgkmcnt(10)
    v_mfma_f32_32x32x16_bf16 v[64:79], v[40:43], v[148:151], v[64:79]
    ds_read_b64_tr_b16 v[32:33], v4 offset:8192
    ds_read_b64_tr_b16 v[34:35], v4 offset:8448
    buffer_load_dwordx4 v[180:183], v2, s[44:47], s4 offen offset:1024 sc1
    s_waitcnt lgkmcnt(10)
    v_mfma_f32_32x32x16_bf16 v[80:95], v[148:151], v[44:47], v[80:95]
    ds_read_b64_tr_b16 v[36:37], v6 offset:8192
    ds_read_b64_tr_b16 v[38:39], v6 offset:8448
    s_waitcnt vmcnt(7)
    s_waitcnt lgkmcnt(10)
    v_mfma_f32_32x32x16_bf16 v[64:79], v[48:51], v[152:155], v[64:79]
    ds_read_b64_tr_b16 v[40:41], v4 offset:9216
    ds_read_b64_tr_b16 v[42:43], v4 offset:9472
    buffer_load_dwordx4 v[184:187], v2, s[44:47], s4 offen offset:2048 sc1
    s_waitcnt lgkmcnt(10)
    v_mfma_f32_32x32x16_bf16 v[80:95], v[152:155], v[52:55], v[80:95]
    ds_read_b64_tr_b16 v[44:45], v6 offset:9216
    ds_read_b64_tr_b16 v[46:47], v6 offset:9472
    s_waitcnt vmcnt(7)
    s_waitcnt lgkmcnt(10)
    v_mfma_f32_32x32x16_bf16 v[64:79], v[56:59], v[156:159], v[64:79]
    ds_read_b64_tr_b16 v[48:49], v4 offset:10240
    ds_read_b64_tr_b16 v[50:51], v4 offset:10496
    buffer_load_dwordx4 v[188:191], v2, s[44:47], s4 offen offset:3072 sc1
    s_waitcnt lgkmcnt(10)
    v_mfma_f32_32x32x16_bf16 v[80:95], v[156:159], v[60:63], v[80:95]
    ds_read_b64_tr_b16 v[52:53], v6 offset:10240
    ds_read_b64_tr_b16 v[54:55], v6 offset:10496
    s_waitcnt vmcnt(7)
    s_waitcnt lgkmcnt(10)
    v_mfma_f32_32x32x16_bf16 v[64:79], v[32:35], v[160:163], v[64:79]
    ds_read_b64_tr_b16 v[56:57], v4 offset:11264
    ds_read_b64_tr_b16 v[58:59], v4 offset:11520
    s_add_u32 s4, s4, 4096
    buffer_load_dwordx4 v[192:195], v2, s[44:47], s4 offen offset:0 sc1
    s_waitcnt lgkmcnt(10)
    v_mfma_f32_32x32x16_bf16 v[80:95], v[160:163], v[36:39], v[80:95]
    ds_read_b64_tr_b16 v[60:61], v6 offset:11264
    ds_read_b64_tr_b16 v[62:63], v6 offset:11520
    s_waitcnt vmcnt(7)
    s_waitcnt lgkmcnt(10)
    v_mfma_f32_32x32x16_bf16 v[64:79], v[40:43], v[164:167], v[64:79]
    ds_read_b64_tr_b16 v[32:33], v4 offset:12288
    ds_read_b64_tr_b16 v[34:35], v4 offset:12544
    buffer_load_dwordx4 v[196:199], v2, s[44:47], s4 offen offset:1024 sc1
    s_waitcnt lgkmcnt(10)
    v_mfma_f32_32x32x16_bf16 v[80:95], v[164:167], v[44:47], v[80:95]
    ds_read_b64_tr_b16 v[36:37], v6 offset:12288
    ds_read_b64_tr_b16 v[38:39], v6 offset:12544
    s_waitcnt vmcnt(7)
    s_waitcnt lgkmcnt(10)
    v_mfma_f32_32x32x16_bf16 v[64:79], v[48:51], v[168:171], v[64:79]
    ds_read_b64_tr_b16 v[40:41], v4 offset:13312
    ds_read_b64_tr_b16 v[42:43], v4 offset:13568
    buffer_load_dwordx4 v[200:203], v2, s[44:47], s4 offen offset:2048 sc1
    s_waitcnt lgkmcnt(10)
    v_mfma_f32_32x32x16_bf16 v[80:95], v[168:171], v[52:55], v[80:95]
    ds_read_b64_tr_b16 v[44:45], v6 offset:13312
    ds_read_b64_tr_b16 v[46:47], v6 offset:13568
    s_waitcnt vmcnt(7)
    s_waitcnt lgkmcnt(10)
    v_mfma_f32_32x32x16_bf16 v[64:79], v[56:59], v[172:175], v[64:79]
    ds_read_b64_tr_b16 v[48:49], v4 offset:14336
    ds_read_b64_tr_b16 v[50:51], v4 offset:14592
    buffer_load_dwordx4 v[204:207], v2, s[44:47], s4 offen offset:3072 sc1
    s_waitcnt lgkmcnt(10)
    v_mfma_f32_32x32x16_bf16 v[80:95], v[172:175], v[60:63], v[80:95]
    ds_read_b64_tr_b16 v[52:53], v6 offset:14336
    ds_read_b64_tr_b16 v[54:55], v6 offset:14592
    s_waitcnt vmcnt(7)
    s_waitcnt lgkmcnt(10)
    v_mfma_f32_32x32x16_bf16 v[64:79], v[32:35], v[176:179], v[64:79]
    ds_read_b64_tr_b16 v[56:57], v4 offset:15360
    ds_read_b64_tr_b16 v[58:59], v4 offset:15616
    s_add_u32 s4, s4, 4096
    buffer_load_dwordx4 v[208:211], v2, s[44:47], s4 offen offset:0 sc1
    s_waitcnt lgkmcnt(10)
    v_mfma_f32_32x32x16_bf16 v[80:95], v[176:179], v[36:39], v[80:95]
    ds_read_b64_tr_b16 v[60:61], v6 offset:15360
    ds_read_b64_tr_b16 v[62:63], v6 offset:15616
    s_waitcnt vmcnt(7)
    s_waitcnt lgkmcnt(10)
    v_mfma_f32_32x32x16_bf16 v[64:79], v[40:43], v[180:183], v[64:79]
    ds_read_b64_tr_b16 v[32:33], v4 offset:16384
    ds_read_b64_tr_b16 v[34:35], v4 offset:16640
    buffer_load_dwordx4 v[212:215], v2, s[44:47], s4 offen offset:1024 sc1
    s_waitcnt lgkmcnt(10)
    v_mfma_f32_32x32x16_bf16 v[80:95], v[180:183], v[44:47], v[80:95]
    ds_read_b64_tr_b16 v[36:37], v6 offset:16384
    ds_read_b64_tr_b16 v[38:39], v6 offset:16640
    s_waitcnt vmcnt(7)
    s_waitcnt lgkmcnt(10)
    v_mfma_f32_32x32x16_bf16 v[64:79], v[48:51], v[184:187], v[64:79]
    ds_read_b64_tr_b16 v[40:41], v4 offset:17408
    ds_read_b64_tr_b16 v[42:43], v4 offset:17664
    buffer_load_dwordx4 v[216:219], v2, s[44:47], s4 offen offset:2048 sc1
    s_waitcnt lgkmcnt(10)
    v_mfma_f32_32x32x16_bf16 v[80:95], v[184:187], v[52:55], v[80:95]
    ds_read_b64_tr_b16 v[44:45], v6 offset:17408
    ds_read_b64_tr_b16 v[46:47], v6 offset:17664
    s_waitcnt vmcnt(7)
    s_waitcnt lgkmcnt(10)
    v_mfma_f32_32x32x16_bf16 v[64:79], v[56:59], v[188:191], v[64:79]
    ds_read_b64_tr_b16 v[48:49], v4 offset:18432
    ds_read_b64_tr_b16 v[50:51], v4 offset:18688
    buffer_load_dwordx4 v[220:223], v2, s[44:47], s4 offen offset:3072 sc1
    s_waitcnt lgkmcnt(10)
    v_mfma_f32_32x32x16_bf16 v[80:95], v[188:191], v[60:63], v[80:95]
    ds_read_b64_tr_b16 v[52:53], v6 offset:18432
    ds_read_b64_tr_b16 v[54:55], v6 offset:18688
    s_waitcnt vmcnt(7)
    s_waitcnt lgkmcnt(10)
    v_mfma_f32_32x32x16_bf16 v[64:79], v[32:35], v[192:195], v[64:79]
    ds_read_b64_tr_b16 v[56:57], v4 offset:19456
    ds_read_b64_tr_b16 v[58:59], v4 offset:19712
    s_add_u32 s4, s4, 4096
    buffer_load_dwordx4 v[224:227], v2, s[44:47], s4 offen offset:0 sc1
    s_waitcnt lgkmcnt(10)
    v_mfma_f32_32x32x16_bf16 v[80:95], v[192:195], v[36:39], v[80:95]
    ds_read_b64_tr_b16 v[60:61], v6 offset:19456
    ds_read_b64_tr_b16 v[62:63], v6 offset:19712
    s_waitcnt vmcnt(7)
    s_waitcnt lgkmcnt(10)
    v_mfma_f32_32x32x16_bf16 v[64:79], v[40:43], v[196:199], v[64:79]
    ds_read_b64_tr_b16 v[32:33], v4 offset:20480
    ds_read_b64_tr_b16 v[34:35], v4 offset:20736
    buffer_load_dwordx4 v[228:231], v2, s[44:47], s4 offen offset:1024 sc1
    s_waitcnt lgkmcnt(10)
    v_mfma_f32_32x32x16_bf16 v[80:95], v[196:199], v[44:47], v[80:95]
    ds_read_b64_tr_b16 v[36:37], v6 offset:20480
    ds_read_b64_tr_b16 v[38:39], v6 offset:20736
    s_waitcnt vmcnt(7)
    s_waitcnt lgkmcnt(10)
    v_mfma_f32_32x32x16_bf16 v[64:79], v[48:51], v[200:203], v[64:79]
    ds_read_b64_tr_b16 v[40:41], v4 offset:21504
    ds_read_b64_tr_b16 v[42:43], v4 offset:21760
    buffer_load_dwordx4 v[232:235], v2, s[44:47], s4 offen offset:2048 sc1
    s_waitcnt lgkmcnt(10)
    v_mfma_f32_32x32x16_bf16 v[80:95], v[200:203], v[52:55], v[80:95]
    ds_read_b64_tr_b16 v[44:45], v6 offset:21504
    ds_read_b64_tr_b16 v[46:47], v6 offset:21760
    s_waitcnt vmcnt(7)
    s_waitcnt lgkmcnt(10)
    v_mfma_f32_32x32x16_bf16 v[64:79], v[56:59], v[204:207], v[64:79]
    ds_read_b64_tr_b16 v[48:49], v4 offset:22528
    ds_read_b64_tr_b16 v[50:51], v4 offset:22784
    buffer_load_dwordx4 v[236:239], v2, s[44:47], s4 offen offset:3072 sc1
    s_waitcnt lgkmcnt(10)
    v_mfma_f32_32x32x16_bf16 v[80:95], v[204:207], v[60:63], v[80:95]
    ds_read_b64_tr_b16 v[52:53], v6 offset:22528
    ds_read_b64_tr_b16 v[54:55], v6 offset:22784
    s_waitcnt vmcnt(7)
    s_waitcnt lgkmcnt(10)
    v_mfma_f32_32x32x16_bf16 v[64:79], v[32:35], v[208:211], v[64:79]
    ds_read_b64_tr_b16 v[56:57], v4 offset:23552
    ds_read_b64_tr_b16 v[58:59], v4 offset:23808
    s_add_u32 s4, s4, 4096
    buffer_load_dwordx4 v[240:243], v2, s[44:47], s4 offen offset:0 sc1
    s_waitcnt lgkmcnt(10)
    v_mfma_f32_32x32x16_bf16 v[80:95], v[208:211], v[36:39], v[80:95]
    ds_read_b64_tr_b16 v[60:61], v6 offset:23552
    ds_read_b64_tr_b16 v[62:63], v6 offset:23808
    s_waitcnt vmcnt(7)
    s_waitcnt lgkmcnt(10)
    v_mfma_f32_32x32x16_bf16 v[64:79], v[40:43], v[212:215], v[64:79]
    ds_read_b64_tr_b16 v[32:33], v4 offset:24576
    ds_read_b64_tr_b16 v[34:35], v4 offset:24832
    buffer_load_dwordx4 v[244:247], v2, s[44:47], s4 offen offset:1024 sc1
    s_waitcnt lgkmcnt(10)
    v_mfma_f32_32x32x16_bf16 v[80:95], v[212:215], v[44:47], v[80:95]
    ds_read_b64_tr_b16 v[36:37], v6 offset:24576
    ds_read_b64_tr_b16 v[38:39], v6 offset:24832
    s_waitcnt vmcnt(7)
    s_waitcnt lgkmcnt(10)
    v_mfma_f32_32x32x16_bf16 v[64:79], v[48:51], v[216:219], v[64:79]
    ds_read_b64_tr_b16 v[40:41], v4 offset:25600
    ds_read_b64_tr_b16 v[42:43], v4 offset:25856
    buffer_load_dwordx4 v[248:251], v2, s[44:47], s4 offen offset:2048 sc1
    s_waitcnt lgkmcnt(10)
    v_mfma_f32_32x32x16_bf16 v[80:95], v[216:219], v[52:55], v[80:95]
    ds_read_b64_tr_b16 v[44:45], v6 offset:25600
    ds_read_b64_tr_b16 v[46:47], v6 offset:25856
    s_waitcnt vmcnt(7)
    s_waitcnt lgkmcnt(10)
    v_mfma_f32_32x32x16_bf16 v[64:79], v[56:59], v[220:223], v[64:79]
    ds_read_b64_tr_b16 v[48:49], v4 offset:26624
    ds_read_b64_tr_b16 v[50:51], v4 offset:26880
    buffer_load_dwordx4 v[252:255], v2, s[44:47], s4 offen offset:3072 sc1
    ds_write_b8 v7, v9 offset:448
    s_getpc_b64 s[6:7]
Lpc_18:
    s_lshl_b32 s8, s73, 2
    s_add_u32 s8, s8, s74
    s_mul_i32 s8, s8, 384
    s_min_u32 s8, s8, L_codeend-L_p1code-384
    s_add_u32 s6, s6, s8
    s_addc_u32 s7, s7, 0
    s_add_u32 s6, s6, L_p1code-Lpc_18
    s_addc_u32 s7, s7, 0
    v_lshlrev_b32 v21, 7, v1
    s_mov_b64 exec, 7
    global_load_dword v21, v21, s[6:7]
    s_mov_b64 exec, -1
    s_waitcnt lgkmcnt(11)
    v_mfma_f32_32x32x16_bf16 v[80:95], v[220:223], v[60:63], v[80:95]
    ds_read_b64_tr_b16 v[52:53], v6 offset:26624
    ds_read_b64_tr_b16 v[54:55], v6 offset:26880
    s_waitcnt vmcnt(8)
    s_waitcnt lgkmcnt(11)
    v_mfma_f32_32x32x16_bf16 v[64:79], v[32:35], v[224:227], v[64:79]
    ds_read_b64_tr_b16 v[56:57], v4 offset:27648
    ds_read_b64_tr_b16 v[58:59], v4 offset:27904
    s_waitcnt lgkmcnt(11)
    v_mfma_f32_32x32x16_bf16 v[80:95], v[224:227], v[36:39], v[80:95]
    ds_read_b64_tr_b16 v[60:61], v6 offset:27648
    ds_read_b64_tr_b16 v[62:63], v6 offset:27904
    s_waitcnt vmcnt(7)
    s_waitcnt lgkmcnt(11)
    v_mfma_f32_32x32x16_bf16 v[64:79], v[40:43], v[228:231], v[64:79]
    ds_read_b64_tr_b16 v[32:33], v4 offset:28672
    ds_read_b64_tr_b16 v[34:35], v4 offset:28928
    s_waitcnt lgkmcnt(11)
    v_mfma_f32_32x32x16_bf16 v[80:95], v[228:231], v[44:47], v[80:95]
    ds_read_b64_tr_b16 v[36:37], v6 offset:28672
    ds_read_b64_tr_b16 v[38:39], v6 offset:28928
    s_waitcnt vmcnt(6)
    s_waitcnt lgkmcnt(11)
    v_mfma_f32_32x32x16_bf16 v[64:79], v[48:51], v[232:235], v[64:79]
    ds_read_b64_tr_b16 v[40:41], v4 offset:29696
    ds_read_b64_tr_b16 v[42:43], v4 offset:29952
    s_waitcnt lgkmcnt(10)
    v_mfma_f32_32x32x16_bf16 v[80:95], v[232:235], v[52:55], v[80:95]
    ds_read_b64_tr_b16 v[44:45], v6 offset:29696
    ds_read_b64_tr_b16 v[46:47], v6 offset:29952
    s_waitcnt vmcnt(5)
    s_waitcnt lgkmcnt(10)
    v_mfma_f32_32x32x16_bf16 v[64:79], v[56:59], v[236:239], v[64:79]
    ds_read_b64_tr_b16 v[48:49], v4 offset:30720
    ds_read_b64_tr_b16 v[50:51], v4 offset:30976
    s_waitcnt lgkmcnt(10)
    v_mfma_f32_32x32x16_bf16 v[80:95], v[236:239], v[60:63], v[80:95]
    ds_read_b64_tr_b16 v[52:53], v6 offset:30720
    ds_read_b64_tr_b16 v[54:55], v6 offset:30976
    s_waitcnt vmcnt(4)
    s_waitcnt lgkmcnt(10)
    v_mfma_f32_32x32x16_bf16 v[64:79], v[32:35], v[240:243], v[64:79]
    ds_read_b64_tr_b16 v[56:57], v4 offset:31744
    ds_read_b64_tr_b16 v[58:59], v4 offset:32000
    s_waitcnt lgkmcnt(10)
    v_mfma_f32_32x32x16_bf16 v[80:95], v[240:243], v[36:39], v[80:95]
    ds_read_b64_tr_b16 v[60:61], v6 offset:31744
    ds_read_b64_tr_b16 v[62:63], v6 offset:32000
    ds_write_b8 v7, v9 offset:16
    s_waitcnt vmcnt(3)
    s_waitcnt lgkmcnt(11)
    v_mfma_f32_32x32x16_bf16 v[64:79], v[40:43], v[244:247], v[64:79]
    s_waitcnt lgkmcnt(9)
    v_mfma_f32_32x32x16_bf16 v[80:95], v[244:247], v[44:47], v[80:95]
    s_waitcnt vmcnt(2)
    s_waitcnt lgkmcnt(7)
    v_mfma_f32_32x32x16_bf16 v[64:79], v[48:51], v[248:251], v[64:79]
    s_waitcnt lgkmcnt(5)
    v_mfma_f32_32x32x16_bf16 v[80:95], v[248:251], v[52:55], v[80:95]
    s_waitcnt vmcnt(1)
    s_waitcnt lgkmcnt(3)
    v_mfma_f32_32x32x16_bf16 v[64:79], v[56:59], v[252:255], v[64:79]
    s_waitcnt lgkmcnt(1)
    v_mfma_f32_32x32x16_bf16 v[80:95], v[252:255], v[60:63], v[80:95]
L_p1code:
    s_nop 9
    v_cvt_pk_bf16_f32 v32, v64, v65
    v_cvt_pk_bf16_f32 v33, v66, v67
    v_cvt_pk_bf16_f32 v34, v68, v69
    v_cvt_pk_bf16_f32 v35, v70, v71
    s_nop 1
    v_mfma_f32_32x32x16_bf16 v[96:111], v[12:15], v[32:35], 0
    v_cvt_pk_bf16_f32 v36, v72, v73
    v_cvt_pk_bf16_f32 v37, v74, v75
    v_cvt_pk_bf16_f32 v38, v76, v77
    v_cvt_pk_bf16_f32 v39, v78, v79
    s_nop 1
    v_mfma_f32_32x32x16_bf16 v[96:111], v[16:19], v[36:39], v[96:111]
    v_cvt_pk_bf16_f32 v40, v80, v81
    v_cvt_pk_bf16_f32 v41, v82, v83
    v_cvt_pk_bf16_f32 v42, v84, v85
    v_cvt_pk_bf16_f32 v43, v86, v87
    v_cvt_pk_bf16_f32 v44, v88, v89
    v_cvt_pk_bf16_f32 v45, v90, v91
    v_cvt_pk_bf16_f32 v46, v92, v93
    v_cvt_pk_bf16_f32 v47, v94, v95
    ds_write_b128 v28, v[40:43]
    ds_write_b128 v28, v[44:47] offset:1040
    s_nop 1
    v_max3_f32 v60, v96, v97, v98
    v_max3_f32 v61, -v96, -v97, -v98
    v_max3_f32 v60, v60, v99, v100
    v_max3_f32 v61, v61, -v99, -v100
    v_max3_f32 v60, v60, v101, v102
    v_max3_f32 v61, v61, -v101, -v102
    v_max_f32 v60, v60, v103
    v_max_f32_e64 v61, v61, -v103
    v_max3_f32 v62, v104, v105, v106
    v_max3_f32 v63, -v104, -v105, -v106
    v_max3_f32 v62, v62, v107, v108
    v_max3_f32 v63, v63, -v107, -v108
    v_max3_f32 v62, v62, v109, v110
    v_max3_f32 v63, v63, -v109, -v110
    v_max_f32 v62, v62, v111
    v_max_f32_e64 v63, v63, -v111
    v_permlane32_swap_b32 v60, v61
    s_nop 0
    v_permlane32_swap_b32 v62, v63
    v_max_f32 v60, v60, v61
    v_max_f32 v62, v62, v63
    v_mul_f32 v60, s80, v60
    v_mul_f32 v62, s80, v62
    v_mov_b32 v61, v60
    v_mov_b32 v63, v62
    s_nop 0
    v_permlane32_swap_b32 v60, v61
    v_permlane32_swap_b32 v62, v63
    v_pk_fma_f32 v[64:65], v[96:97], s[80:81], v[60:61] op_sel_hi:[1,1,0] neg_lo:[0,0,1] neg_hi:[0,0,1]
    v_pk_fma_f32 v[66:67], v[98:99], s[80:81], v[60:61] op_sel_hi:[1,1,0] neg_lo:[0,0,1] neg_hi:[0,0,1]
    v_pk_fma_f32 v[68:69], v[100:101], s[80:81], v[60:61] op_sel_hi:[1,1,0] neg_lo:[0,0,1] neg_hi:[0,0,1]
    v_pk_fma_f32 v[70:71], v[102:103], s[80:81], v[60:61] op_sel_hi:[1,1,0] neg_lo:[0,0,1] neg_hi:[0,0,1]
    v_pk_fma_f32 v[72:73], v[96:97], s[80:81], v[60:61] op_sel:[0,0,1] neg_lo:[1,0,1] neg_hi:[1,0,1]
    v_pk_fma_f32 v[74:75], v[98:99], s[80:81], v[60:61] op_sel:[0,0,1] neg_lo:[1,0,1] neg_hi:[1,0,1]
    v_pk_fma_f32 v[76:77], v[100:101], s[80:81], v[60:61] op_sel:[0,0,1] neg_lo:[1,0,1] neg_hi:[1,0,1]
    v_pk_fma_f32 v[78:79], v[102:103], s[80:81], v[60:61] op_sel:[0,0,1] neg_lo:[1,0,1] neg_hi:[1,0,1]
    v_pk_fma_f32 v[80:81], v[104:105], s[80:81], v[62:63] op_sel_hi:[1,1,0] neg_lo:[0,0,1] neg_hi:[0,0,1]
    v_pk_fma_f32 v[82:83], v[106:107], s[80:81], v[62:63] op_sel_hi:[1,1,0] neg_lo:[0,0,1] neg_hi:[0,0,1]
    v_pk_fma_f32 v[84:85], v[108:109], s[80:81], v[62:63] op_sel_hi:[1,1,0] neg_lo:[0,0,1] neg_hi:[0,0,1]
    v_pk_fma_f32 v[86:87], v[110:111], s[80:81], v[62:63] op_sel_hi:[1,1,0] neg_lo:[0,0,1] neg_hi:[0,0,1]
    v_pk_fma_f32 v[88:89], v[104:105], s[80:81], v[62:63] op_sel:[0,0,1] neg_lo:[1,0,1] neg_hi:[1,0,1]
    v_pk_fma_f32 v[90:91], v[106:107], s[80:81], v[62:63] op_sel:[0,0,1] neg_lo:[1,0,1] neg_hi:[1,0,1]
    v_pk_fma_f32 v[92:93], v[108:109], s[80:81], v[62:63] op_sel:[0,0,1] neg_lo:[1,0,1] neg_hi:[1,0,1]
    v_pk_fma_f32 v[94:95], v[110:111], s[80:81], v[62:63] op_sel:[0,0,1] neg_lo:[1,0,1] neg_hi:[1,0,1]
    v_exp_f32 v64, v64
    v_exp_f32 v65, v65
    v_exp_f32 v66, v66
    v_exp_f32 v67, v67
    v_exp_f32 v68, v68
    v_exp_f32 v69, v69
    v_exp_f32 v70, v70
    v_exp_f32 v71, v71
    v_exp_f32 v72, v72
    v_exp_f32 v73, v73
    v_exp_f32 v74, v74
    v_exp_f32 v75, v75
    v_exp_f32 v76, v76
    v_exp_f32 v77, v77
    v_exp_f32 v78, v78
    v_exp_f32 v79, v79
    v_exp_f32 v80, v80
    v_exp_f32 v81, v81
    v_exp_f32 v82, v82
    v_exp_f32 v83, v83
    v_exp_f32 v84, v84
    v_exp_f32 v85, v85
    v_exp_f32 v86, v86
    v_exp_f32 v87, v87
    v_exp_f32 v88, v88
    v_exp_f32 v89, v89
    v_exp_f32 v90, v90
    v_exp_f32 v91, v91
    v_exp_f32 v92, v92
    v_exp_f32 v93, v93
    v_exp_f32 v94, v94
    v_exp_f32 v95, v95
    v_pk_add_f32 v[96:97], v[64:65], v[66:67]
    v_pk_add_f32 v[98:99], v[68:69], v[70:71]
    v_pk_add_f32 v[100:101], v[72:73], v[74:75]
    v_pk_add_f32 v[102:103], v[76:77], v[78:79]
    v_pk_add_f32 v[104:105], v[80:81], v[82:83]
    v_pk_add_f32 v[106:107], v[84:85], v[86:87]
    v_pk_add_f32 v[108:109], v[88:89], v[90:91]
    v_pk_add_f32 v[110:111], v[92:93], v[94:95]
    v_pk_add_f32 v[96:97], v[96:97], v[98:99]
    v_pk_add_f32 v[100:101], v[100:101], v[102:103]
    v_pk_add_f32 v[104:105], v[104:105], v[106:107]
    v_pk_add_f32 v[108:109], v[108:109], v[110:111]
    v_add_f32 v60, v96, v97
    v_add_f32 v61, v100, v101
    v_add_f32 v62, v104, v105
    v_add_f32 v63, v108, v109
    v_permlane32_swap_b32 v60, v61
    s_nop 0
    v_permlane32_swap_b32 v62, v63
    v_add_f32 v60, v60, v61
    v_add_f32 v62, v62, v63
    v_rcp_f32 v60, v60
    v_rcp_f32 v62, v62
    v_mov_b32 v61, v60
    v_mov_b32 v63, v62
    s_nop 0
    v_permlane32_swap_b32 v60, v61
    v_permlane32_swap_b32 v62, v63
    v_pk_mul_f32 v[64:65], v[64:65], v[60:61] op_sel_hi:[1,0]
    v_pk_mul_f32 v[66:67], v[66:67], v[60:61] op_sel_hi:[1,0]
    v_pk_mul_f32 v[68:69], v[68:69], v[60:61] op_sel_hi:[1,0]
    v_pk_mul_f32 v[70:71], v[70:71], v[60:61] op_sel_hi:[1,0]
    v_pk_mul_f32 v[72:73], v[72:73], v[60:61] op_sel:[0,1]
    v_pk_mul_f32 v[74:75], v[74:75], v[60:61] op_sel:[0,1]
    v_pk_mul_f32 v[76:77], v[76:77], v[60:61] op_sel:[0,1]
    v_pk_mul_f32 v[78:79], v[78:79], v[60:61] op_sel:[0,1]
    v_pk_mul_f32 v[80:81], v[80:81], v[62:63] op_sel_hi:[1,0]
    v_pk_mul_f32 v[82:83], v[82:83], v[62:63] op_sel_hi:[1,0]
    v_pk_mul_f32 v[84:85], v[84:85], v[62:63] op_sel_hi:[1,0]
    v_pk_mul_f32 v[86:87], v[86:87], v[62:63] op_sel_hi:[1,0]
    v_pk_mul_f32 v[88:89], v[88:89], v[62:63] op_sel:[0,1]
    v_pk_mul_f32 v[90:91], v[90:91], v[62:63] op_sel:[0,1]
    v_pk_mul_f32 v[92:93], v[92:93], v[62:63] op_sel:[0,1]
    v_pk_mul_f32 v[94:95], v[94:95], v[62:63] op_sel:[0,1]
    v_cvt_pk_bf16_f32 v112, v64, v65
    v_cvt_pk_bf16_f32 v113, v66, v67
    ds_write_b64 v24, v[112:113] offset:0
    v_cvt_pk_bf16_f32 v114, v68, v69
    v_cvt_pk_bf16_f32 v115, v70, v71
    ds_write_b64 v25, v[114:115] offset:0
    v_cvt_pk_bf16_f32 v116, v72, v73
    v_cvt_pk_bf16_f32 v117, v74, v75
    ds_write_b64 v26, v[116:117] offset:0
    v_cvt_pk_bf16_f32 v118, v76, v77
    v_cvt_pk_bf16_f32 v119, v78, v79
    ds_write_b64 v27, v[118:119] offset:0
    v_cvt_pk_bf16_f32 v120, v80, v81
    v_cvt_pk_bf16_f32 v121, v82, v83
    ds_write_b64 v24, v[120:121] offset:8192
    v_cvt_pk_bf16_f32 v122, v84, v85
    v_cvt_pk_bf16_f32 v123, v86, v87
    ds_write_b64 v25, v[122:123] offset:8192
    v_cvt_pk_bf16_f32 v124, v88, v89
    v_cvt_pk_bf16_f32 v125, v90, v91
    ds_write_b64 v26, v[124:125] offset:8192
    v_cvt_pk_bf16_f32 v126, v92, v93
    v_cvt_pk_bf16_f32 v127, v94, v95
    ds_write_b64 v27, v[126:127] offset:8192
    ds_write_b8 v7, v9 offset:32
    s_cmp_ge_u32 s74, 2
    s_cbranch_scc1 Lq_19
Lev_20:
    ds_read_b32 v20, v8 offset:32
    s_waitcnt lgkmcnt(0)
    v_readfirstlane_b32 s98, v20
    s_nop 0
    s_cmp_eq_u32 s98, 0x01010101
    s_cbranch_scc1 Levd_21
    s_sub_u32 s77, s77, 1
    s_cbranch_scc1 L_end
    s_branch Lev_20
Levd_21:
    ds_read_b128 v[64:67], v31 offset:0
    ds_read_b64_tr_b16 v[32:33], v29 offset:0
    ds_read_b64_tr_b16 v[34:35], v30 offset:512
    ds_read_b128 v[68:71], v31 offset:1040
    ds_read_b64_tr_b16 v[36:37], v29 offset:1024
    ds_read_b64_tr_b16 v[38:39], v30 offset:1536
    ds_read_b128 v[72:75], v31 offset:2080
    ds_read_b64_tr_b16 v[40:41], v29 offset:2048
    ds_read_b64_tr_b16 v[42:43], v30 offset:2560
    ds_read_b128 v[76:79], v31 offset:3120
    ds_read_b64_tr_b16 v[44:45], v29 offset:3072
    ds_read_b64_tr_b16 v[46:47], v30 offset:3584
    ds_read_b128 v[80:83], v31 offset:4160
    ds_read_b64_tr_b16 v[48:49], v29 offset:4096
    ds_read_b64_tr_b16 v[50:51], v30 offset:4608
    s_waitcnt lgkmcnt(12)
    v_mfma_f32_32x32x16_bf16 v[96:111], v[32:35], v[64:67], 0
    ds_read_b128 v[84:87], v31 offset:5200
    ds_read_b64_tr_b16 v[52:53], v29 offset:5120
    ds_read_b64_tr_b16 v[54:55], v30 offset:5632
    s_waitcnt lgkmcnt(12)
    v_mfma_f32_32x32x16_bf16 v[96:111], v[36:39], v[68:71], v[96:111]
    ds_read_b128 v[88:91], v31 offset:6240
    ds_read_b64_tr_b16 v[56:57], v29 offset:6144
    ds_read_b64_tr_b16 v[58:59], v30 offset:6656
    s_waitcnt lgkmcnt(12)
    v_mfma_f32_32x32x16_bf16 v[96:111], v[40:43], v[72:75], v[96:111]
    ds_read_b128 v[92:95], v31 offset:7280
    ds_read_b64_tr_b16 v[60:61], v29 offset:7168
    ds_read_b64_tr_b16 v[62:63], v30 offset:7680
    s_waitcnt lgkmcnt(12)
    v_mfma_f32_32x32x16_bf16 v[96:111], v[44:47], v[76:79], v[96:111]
    s_waitcnt lgkmcnt(9)
    v_mfma_f32_32x32x16_bf16 v[96:111], v[48:51], v[80:83], v[96:111]
    s_waitcnt lgkmcnt(6)
    v_mfma_f32_32x32x16_bf16 v[96:111], v[52:55], v[84:87], v[96:111]
    s_waitcnt lgkmcnt(3)
    v_mfma_f32_32x32x16_bf16 v[96:111], v[56:59], v[88:91], v[96:111]
    s_waitcnt lgkmcnt(0)
    v_mfma_f32_32x32x16_bf16 v[96:111], v[60:63], v[92:95], v[96:111]
    v_mov_b32 v115, s75
    v_mov_b32 v119, s75
    v_mov_b32 v123, s75
    v_mov_b32 v127, s75
    v_mov_b32 v122, 0
    s_add_u32 s3, s68, 0x4500
    s_add_u32 s4, s68, 0x8a00
    s_nop 4
    v_cvt_pk_bf16_f32 v112, v96, v97
    v_cvt_pk_bf16_f32 v113, v98, v99
    v_cvt_pk_bf16_f32 v114, v100, v101
    v_cvt_pk_bf16_f32 v116, v102, v103
    v_cvt_pk_bf16_f32 v117, v104, v105
    v_cvt_pk_bf16_f32 v118, v106, v107
    v_cvt_pk_bf16_f32 v120, v108, v109
    v_cvt_pk_bf16_f32 v121, v110, v111
    s_mov_b64 exec, s[60:61]
    buffer_store_dwordx4 v[112:115], v2, s[44:47], s68 offen sc1
    buffer_store_dwordx4 v[116:119], v2, s[44:47], s3 offen sc1
    buffer_store_dwordx4 v[120:123], v2, s[44:47], s4 offen sc1
    s_mov_b64 exec, s[66:67]
    v_cndmask_b32 v124, v120, v116, s[64:65]
    v_cndmask_b32 v125, v121, v117, s[64:65]
    v_cndmask_b32 v126, v122, v118, s[64:65]
    v_cndmask_b32 v124, v124, v112, s[62:63]
    v_cndmask_b32 v125, v125, v113, s[62:63]
    v_cndmask_b32 v126, v126, v114, s[62:63]
    buffer_store_dwordx4 v[124:127], v10, s[44:47], s69 offen sc1
    s_mov_b64 exec, -1
Lq_19:
    s_setprio 1
Lev_22:
    ds_read_b32 v20, v8 offset:464
    s_waitcnt lgkmcnt(0)
    v_readfirstlane_b32 s98, v20
    s_nop 0
    s_cmp_eq_u32 s98, 0x01010101
    s_cbranch_scc1 Levd_23
    s_sub_u32 s77, s77, 1
    s_cbranch_scc1 L_end
    s_branch Lev_22
Levd_23:
    ds_read_b64_tr_b16 v[32:33], v4 offset:32768
    ds_read_b64_tr_b16 v[34:35], v4 offset:33024
    ds_read_b64_tr_b16 v[36:37], v4 offset:33792
    ds_read_b64_tr_b16 v[38:39], v4 offset:34048
    ds_read_b64_tr_b16 v[40:41], v4 offset:34816
    ds_read_b64_tr_b16 v[42:43], v4 offset:35072
    ds_read_b64_tr_b16 v[44:45], v4 offset:35840
    ds_read_b64_tr_b16 v[46:47], v4 offset:36096
    ds_read_b64_tr_b16 v[48:49], v4 offset:36864
    ds_read_b64_tr_b16 v[50:51], v4 offset:37120
    ds_read_b64_tr_b16 v[52:53], v4 offset:37888
    ds_read_b64_tr_b16 v[54:55], v4 offset:38144
    s_waitcnt lgkmcnt(10)
    v_mfma_f32_32x32x16_bf16 v[64:79], v[32:35], v[128:131], 0
    ds_read_b64_tr_b16 v[56:57], v4 offset:38912
    ds_read_b64_tr_b16 v[58:59], v4 offset:39168
    s_waitcnt lgkmcnt(10)
    v_mfma_f32_32x32x16_bf16 v[64:79], v[36:39], v[132:135], v[64:79]
    ds_read_b64_tr_b16 v[32:33], v4 offset:39936
    ds_read_b64_tr_b16 v[34:35], v4 offset:40192
    s_waitcnt lgkmcnt(10)
    v_mfma_f32_32x32x16_bf16 v[64:79], v[40:43], v[136:139], v[64:79]
    ds_read_b64_tr_b16 v[36:37], v4 offset:40960
    ds_read_b64_tr_b16 v[38:39], v4 offset:41216
    s_waitcnt lgkmcnt(10)
    v_mfma_f32_32x32x16_bf16 v[64:79], v[44:47], v[140:143], v[64:79]
    ds_read_b64_tr_b16 v[40:41], v4 offset:41984
    ds_read_b64_tr_b16 v[42:43], v4 offset:42240
    s_waitcnt lgkmcnt(10)
    v_mfma_f32_32x32x16_bf16 v[64:79], v[48:51], v[144:147], v[64:79]
    ds_read_b64_tr_b16 v[44:45], v4 offset:43008
    ds_read_b64_tr_b16 v[46:47], v4 offset:43264
    s_waitcnt lgkmcnt(10)
    v_mfma_f32_32x32x16_bf16 v[64:79], v[52:55], v[148:151], v[64:79]
    ds_read_b64_tr_b16 v[48:49], v4 offset:44032
    ds_read_b64_tr_b16 v[50:51], v4 offset:44288
    s_waitcnt lgkmcnt(10)
    v_mfma_f32_32x32x16_bf16 v[64:79], v[56:59], v[152:155], v[64:79]
    ds_read_b64_tr_b16 v[52:53], v4 offset:45056
    ds_read_b64_tr_b16 v[54:55], v4 offset:45312
    s_waitcnt lgkmcnt(10)
    v_mfma_f32_32x32x16_bf16 v[64:79], v[32:35], v[156:159], v[64:79]
    ds_read_b64_tr_b16 v[56:57], v4 offset:46080
    ds_read_b64_tr_b16 v[58:59], v4 offset:46336
    s_waitcnt lgkmcnt(10)
    v_mfma_f32_32x32x16_bf16 v[64:79], v[36:39], v[160:163], v[64:79]
    ds_read_b64_tr_b16 v[32:33], v4 offset:47104
    ds_read_b64_tr_b16 v[34:35], v4 offset:47360
    s_waitcnt lgkmcnt(10)
    v_mfma_f32_32x32x16_bf16 v[64:79], v[40:43], v[164:167], v[64:79]
    ds_read_b64_tr_b16 v[36:37], v4 offset:48128
    ds_read_b64_tr_b16 v[38:39], v4 offset:48384
    s_waitcnt lgkmcnt(10)
    v_mfma_f32_32x32x16_bf16 v[64:79], v[44:47], v[168:171], v[64:79]
    ds_read_b64_tr_b16 v[40:41], v4 offset:49152
    ds_read_b64_tr_b16 v[42:43], v4 offset:49408
    s_waitcnt lgkmcnt(10)
    v_mfma_f32_32x32x16_bf16 v[64:79], v[48:51], v[172:175], v[64:79]
    ds_read_b64_tr_b16 v[44:45], v4 offset:50176
    ds_read_b64_tr_b16 v[46:47], v4 offset:50432
    s_waitcnt lgkmcnt(10)
    v_mfma_f32_32x32x16_bf16 v[64:79], v[52:55], v[176:179], v[64:79]
    ds_read_b64_tr_b16 v[48:49], v4 offset:51200
    ds_read_b64_tr_b16 v[50:51], v4 offset:51456
    s_waitcnt lgkmcnt(10)
    v_mfma_f32_32x32x16_bf16 v[64:79], v[56:59], v[180:183], v[64:79]
    ds_read_b64_tr_b16 v[52:53], v4 offset:52224
    ds_read_b64_tr_b16 v[54:55], v4 offset:52480
    s_waitcnt lgkmcnt(10)
    v_mfma_f32_32x32x16_bf16 v[64:79], v[32:35], v[184:187], v[64:79]
    ds_read_b64_tr_b16 v[56:57], v4 offset:53248
    ds_read_b64_tr_b16 v[58:59], v4 offset:53504
    s_waitcnt lgkmcnt(10)
    v_mfma_f32_32x32x16_bf16 v[64:79], v[36:39], v[188:191], v[64:79]
    ds_read_b64_tr_b16 v[32:33], v4 offset:54272
    ds_read_b64_tr_b16 v[34:35], v4 offset:54528
    s_waitcnt lgkmcnt(10)
    v_mfma_f32_32x32x16_bf16 v[64:79], v[40:43], v[192:195], v[64:79]
    ds_read_b64_tr_b16 v[36:37], v4 offset:55296
    ds_read_b64_tr_b16 v[38:39], v4 offset:55552
    s_waitcnt lgkmcnt(10)
    v_mfma_f32_32x32x16_bf16 v[64:79], v[44:47], v[196:199], v[64:79]
    ds_read_b64_tr_b16 v[40:41], v4 offset:56320
    ds_read_b64_tr_b16 v[42:43], v4 offset:56576
    s_waitcnt lgkmcnt(10)
    v_mfma_f32_32x32x16_bf16 v[64:79], v[48:51], v[200:203], v[64:79]
    ds_read_b64_tr_b16 v[44:45], v4 offset:57344
    ds_read_b64_tr_b16 v[46:47], v4 offset:57600
    s_waitcnt lgkmcnt(10)
    v_mfma_f32_32x32x16_bf16 v[64:79], v[52:55], v[204:207], v[64:79]
    ds_read_b64_tr_b16 v[48:49], v4 offset:58368
    ds_read_b64_tr_b16 v[50:51], v4 offset:58624
    s_waitcnt lgkmcnt(10)
    v_mfma_f32_32x32x16_bf16 v[64:79], v[56:59], v[208:211], v[64:79]
    ds_read_b64_tr_b16 v[52:53], v4 offset:59392
    ds_read_b64_tr_b16 v[54:55], v4 offset:59648
    s_waitcnt lgkmcnt(10)
    v_mfma_f32_32x32x16_bf16 v[64:79], v[32:35], v[212:215], v[64:79]
    ds_read_b64_tr_b16 v[56:57], v4 offset:60416
    ds_read_b64_tr_b16 v[58:59], v4 offset:60672
    s_waitcnt lgkmcnt(10)
    v_mfma_f32_32x32x16_bf16 v[64:79], v[36:39], v[216:219], v[64:79]
    ds_read_b64_tr_b16 v[32:33], v4 offset:61440
    ds_read_b64_tr_b16 v[34:35], v4 offset:61696
    s_waitcnt lgkmcnt(10)
    v_mfma_f32_32x32x16_bf16 v[64:79], v[40:43], v[220:223], v[64:79]
    ds_read_b64_tr_b16 v[36:37], v4 offset:62464
    ds_read_b64_tr_b16 v[38:39], v4 offset:62720
    s_waitcnt lgkmcnt(10)
    v_mfma_f32_32x32x16_bf16 v[64:79], v[44:47], v[224:227], v[64:79]
    ds_read_b64_tr_b16 v[40:41], v4 offset:63488
    ds_read_b64_tr_b16 v[42:43], v4 offset:63744
    s_waitcnt lgkmcnt(10)
    v_mfma_f32_32x32x16_bf16 v[64:79], v[48:51], v[228:231], v[64:79]
    ds_read_b64_tr_b16 v[44:45], v4 offset:64512
    ds_read_b64_tr_b16 v[46:47], v4 offset:64768
    ds_write_b8 v7, v9 offset:48
    s_waitcnt lgkmcnt(11)
    v_mfma_f32_32x32x16_bf16 v[64:79], v[52:55], v[232:235], v[64:79]
    s_waitcnt lgkmcnt(9)
    v_mfma_f32_32x32x16_bf16 v[64:79], v[56:59], v[236:239], v[64:79]
    s_waitcnt lgkmcnt(7)
    v_mfma_f32_32x32x16_bf16 v[64:79], v[32:35], v[240:243], v[64:79]
    s_waitcnt lgkmcnt(5)
    v_mfma_f32_32x32x16_bf16 v[64:79], v[36:39], v[244:247], v[64:79]
    s_waitcnt lgkmcnt(3)
    v_mfma_f32_32x32x16_bf16 v[64:79], v[40:43], v[248:251], v[64:79]
    s_waitcnt lgkmcnt(1)
    v_mfma_f32_32x32x16_bf16 v[64:79], v[44:47], v[252:255], v[64:79]
    s_add_u32 s3, s74, 2
    s_and_b32 s3, s3, 3
    s_mul_i32 s4, s15, 3
    s_add_u32 s4, s4, s3
    s_mul_i32 s4, s4, 17664
    s_add_u32 s4, s4, 0x100000
    s_lshr_b32 s9, s72, 1
    s_add_u32 s8, s9, 1
    s_and_b32 s8, s8, 3
    s_lshl_b32 s8, s8, 12
    s_add_u32 s5, s4, s8
    s_add_u32 s8, s9, 2
    s_and_b32 s8, s8, 3
    s_lshl_b32 s8, s8, 12
    s_add_u32 s6, s4, s8
    s_add_u32 s8, s9, 3
    s_and_b32 s8, s8, 3
    s_lshl_b32 s8, s8, 12
    s_add_u32 s7, s4, s8
    s_add_u32 s8, s9, 4
    s_and_b32 s8, s8, 3
    s_lshl_b32 s8, s8, 12
    s_add_u32 s4, s4, s8
    s_lshl_b32 s8, s15, 12
    s_add_u32 s8, s8, 0x1e0000
    v_cvt_pk_bf16_f32 v32, v64, v65
    v_cvt_pk_bf16_f32 v33, v66, v67
    v_cvt_pk_bf16_f32 v34, v68, v69
    v_cvt_pk_bf16_f32 v35, v70, v71
    s_nop 1
    v_mfma_f32_32x32x16_bf16 v[96:111], v[12:15], v[32:35], 0
    v_cvt_pk_bf16_f32 v36, v72, v73
    v_cvt_pk_bf16_f32 v37, v74, v75
    v_cvt_pk_bf16_f32 v38, v76, v77
    v_cvt_pk_bf16_f32 v39, v78, v79
    s_nop 1
    v_mfma_f32_32x32x16_bf16 v[96:111], v[16:19], v[36:39], v[96:111]
    v_and_b32 v24, 15, v1
    v_lshlrev_b32 v24, 8, v24
    v_not_b32 v25, v1
    v_bfe_u32 v25, v25, 4, 1
    v_lshl_add_u32 v24, v25, 7, v24
    v_lshrrev_b32 v25, 5, v1
    v_lshl_add_u32 v24, v25, 6, v24
    v_mul_u32_u24 v26, 48, v1
    s_mul_i32 s9, s3, 12
    s_cmp_eq_u32 s3, 3
    s_cselect_b32 s9, 3072, s9
    s_add_u32 s9, s9, 0x20800
    v_add_u32 v25, s9, v26
    v_max3_f32 v60, v96, v97, v98
    v_max3_f32 v61, -v96, -v97, -v98
    v_max3_f32 v60, v60, v99, v100
    v_max3_f32 v61, v61, -v99, -v100
    v_max3_f32 v60, v60, v101, v102
    v_max3_f32 v61, v61, -v101, -v102
    v_max_f32 v60, v60, v103
    v_max_f32_e64 v61, v61, -v103
    v_max3_f32 v62, v104, v105, v106
    v_max3_f32 v63, -v104, -v105, -v106
    v_max3_f32 v62, v62, v107, v108
    v_max3_f32 v63, v63, -v107, -v108
    v_max3_f32 v62, v62, v109, v110
    v_max3_f32 v63, v63, -v109, -v110
    v_max_f32 v62, v62, v111
    v_max_f32_e64 v63, v63, -v111
    v_permlane32_swap_b32 v60, v61
    s_nop 0
    v_permlane32_swap_b32 v62, v63
    v_max_f32 v60, v60, v61
    v_max_f32 v62, v62, v63
    v_mul_f32 v60, s80, v60
    v_mul_f32 v62, s80, v62
    v_mov_b32 v61, v60
    v_mov_b32 v63, v62
    s_nop 0
    v_permlane32_swap_b32 v60, v61
    v_permlane32_swap_b32 v62, v63
    v_pk_fma_f32 v[64:65], v[96:97], s[80:81], v[60:61] op_sel_hi:[1,1,0] neg_lo:[0,0,1] neg_hi:[0,0,1]
    v_pk_fma_f32 v[66:67], v[98:99], s[80:81], v[60:61] op_sel_hi:[1,1,0] neg_lo:[0,0,1] neg_hi:[0,0,1]
    v_pk_fma_f32 v[68:69], v[100:101], s[80:81], v[60:61] op_sel_hi:[1,1,0] neg_lo:[0,0,1] neg_hi:[0,0,1]
    v_pk_fma_f32 v[70:71], v[102:103], s[80:81], v[60:61] op_sel_hi:[1,1,0] neg_lo:[0,0,1] neg_hi:[0,0,1]
    v_pk_fma_f32 v[72:73], v[96:97], s[80:81], v[60:61] op_sel:[0,0,1] neg_lo:[1,0,1] neg_hi:[1,0,1]
    v_pk_fma_f32 v[74:75], v[98:99], s[80:81], v[60:61] op_sel:[0,0,1] neg_lo:[1,0,1] neg_hi:[1,0,1]
    v_pk_fma_f32 v[76:77], v[100:101], s[80:81], v[60:61] op_sel:[0,0,1] neg_lo:[1,0,1] neg_hi:[1,0,1]
    v_pk_fma_f32 v[78:79], v[102:103], s[80:81], v[60:61] op_sel:[0,0,1] neg_lo:[1,0,1] neg_hi:[1,0,1]
    v_pk_fma_f32 v[80:81], v[104:105], s[80:81], v[62:63] op_sel_hi:[1,1,0] neg_lo:[0,0,1] neg_hi:[0,0,1]
    v_pk_fma_f32 v[82:83], v[106:107], s[80:81], v[62:63] op_sel_hi:[1,1,0] neg_lo:[0,0,1] neg_hi:[0,0,1]
    v_pk_fma_f32 v[84:85], v[108:109], s[80:81], v[62:63] op_sel_hi:[1,1,0] neg_lo:[0,0,1] neg_hi:[0,0,1]
    v_pk_fma_f32 v[86:87], v[110:111], s[80:81], v[62:63] op_sel_hi:[1,1,0] neg_lo:[0,0,1] neg_hi:[0,0,1]
    v_pk_fma_f32 v[88:89], v[104:105], s[80:81], v[62:63] op_sel:[0,0,1] neg_lo:[1,0,1] neg_hi:[1,0,1]
    v_pk_fma_f32 v[90:91], v[106:107], s[80:81], v[62:63] op_sel:[0,0,1] neg_lo:[1,0,1] neg_hi:[1,0,1]
    v_pk_fma_f32 v[92:93], v[108:109], s[80:81], v[62:63] op_sel:[0,0,1] neg_lo:[1,0,1] neg_hi:[1,0,1]
    v_pk_fma_f32 v[94:95], v[110:111], s[80:81], v[62:63] op_sel:[0,0,1] neg_lo:[1,0,1] neg_hi:[1,0,1]
    s_cmp_ge_u32 s74, 2
    s_cbranch_scc1 Lel_25
    s_cmp_eq_u32 s74, 1
    s_cbranch_scc1 Lel_24
    buffer_load_dwordx4 v[128:131], v2, s[44:47], s4 offen offset:0 sc1
    buffer_load_dwordx4 v[132:135], v2, s[44:47], s4 offen offset:1024 sc1
    buffer_load_dwordx4 v[136:139], v2, s[44:47], s4 offen offset:2048 sc1
    buffer_load_dwordx4 v[140:143], v2, s[44:47], s4 offen offset:3072 sc1
    buffer_load_dwordx4 v[144:147], v2, s[44:47], s5 offen offset:0 sc1
    buffer_load_dwordx4 v[148:151], v2, s[44:47], s5 offen offset:1024 sc1
    buffer_load_dwordx4 v[152:155], v2, s[44:47], s5 offen offset:2048 sc1
    buffer_load_dwordx4 v[156:159], v2, s[44:47], s5 offen offset:3072 sc1
    buffer_load_dwordx4 v[160:163], v2, s[44:47], s6 offen offset:0 sc1
    buffer_load_dwordx4 v[164:167], v2, s[44:47], s6 offen offset:1024 sc1
    buffer_load_dwordx4 v[168:171], v2, s[44:47], s6 offen offset:2048 sc1
    buffer_load_dwordx4 v[172:175], v2, s[44:47], s6 offen offset:3072 sc1
    buffer_load_dwordx4 v[176:179], v2, s[44:47], s7 offen offset:0 sc1
    buffer_load_dwordx4 v[180:183], v2, s[44:47], s7 offen offset:1024 sc1
    buffer_load_dwordx4 v[184:187], v2, s[44:47], s7 offen offset:2048 sc1
    buffer_load_dwordx4 v[188:191], v2, s[44:47], s7 offen offset:3072 sc1
    s_branch Lel_25
Lel_24:
    buffer_load_dwordx4 v[128:131], v24, s[44:47], s8 offen offset:0 sc1
    buffer_load_dwordx4 v[132:135], v24, s[44:47], s8 offen offset:16 sc1
    buffer_load_dwordx4 v[136:139], v24, s[44:47], s8 offen offset:32 sc1
Lel_25:
    v_exp_f32 v64, v64
    v_exp_f32 v65, v65
    v_exp_f32 v66, v66
    v_exp_f32 v67, v67
    v_exp_f32 v68, v68
    v_exp_f32 v69, v69
    v_exp_f32 v70, v70
    v_exp_f32 v71, v71
    v_exp_f32 v72, v72
    v_exp_f32 v73, v73
    v_exp_f32 v74, v74
    v_exp_f32 v75, v75
    v_exp_f32 v76, v76
    v_exp_f32 v77, v77
    v_exp_f32 v78, v78
    v_exp_f32 v79, v79
    v_exp_f32 v80, v80
    v_exp_f32 v81, v81
    v_exp_f32 v82, v82
    v_exp_f32 v83, v83
    v_exp_f32 v84, v84
    v_exp_f32 v85, v85
    v_exp_f32 v86, v86
    v_exp_f32 v87, v87
    v_exp_f32 v88, v88
    v_exp_f32 v89, v89
    v_exp_f32 v90, v90
    v_exp_f32 v91, v91
    v_exp_f32 v92, v92
    v_exp_f32 v93, v93
    v_exp_f32 v94, v94
    v_exp_f32 v95, v95
    v_pk_add_f32 v[96:97], v[64:65], v[66:67]
    v_pk_add_f32 v[98:99], v[68:69], v[70:71]
    v_pk_add_f32 v[100:101], v[72:73], v[74:75]
    v_pk_add_f32 v[102:103], v[76:77], v[78:79]
    v_pk_add_f32 v[104:105], v[80:81], v[82:83]
    v_pk_add_f32 v[106:107], v[84:85], v[86:87]
    v_pk_add_f32 v[108:109], v[88:89], v[90:91]
    v_pk_add_f32 v[110:111], v[92:93], v[94:95]
    v_pk_add_f32 v[96:97], v[96:97], v[98:99]
    v_pk_add_f32 v[100:101], v[100:101], v[102:103]
    v_pk_add_f32 v[104:105], v[104:105], v[106:107]
    v_pk_add_f32 v[108:109], v[108:109], v[110:111]
    v_add_f32 v60, v96, v97
    v_add_f32 v61, v100, v101
    v_add_f32 v62, v104, v105
    v_add_f32 v63, v108, v109
    v_permlane32_swap_b32 v60, v61
    s_nop 0
    v_permlane32_swap_b32 v62, v63
    v_add_f32 v60, v60, v61
    v_add_f32 v62, v62, v63
    v_rcp_f32 v60, v60
    v_rcp_f32 v62, v62
    v_mov_b32 v61, v60
    v_mov_b32 v63, v62
    s_nop 0
    v_permlane32_swap_b32 v60, v61
    v_permlane32_swap_b32 v62, v63
    v_pk_mul_f32 v[64:65], v[64:65], v[60:61] op_sel_hi:[1,0]
    v_pk_mul_f32 v[66:67], v[66:67], v[60:61] op_sel_hi:[1,0]
    v_pk_mul_f32 v[68:69], v[68:69], v[60:61] op_sel_hi:[1,0]
    v_pk_mul_f32 v[70:71], v[70:71], v[60:61] op_sel_hi:[1,0]
    v_pk_mul_f32 v[72:73], v[72:73], v[60:61] op_sel:[0,1]
    v_pk_mul_f32 v[74:75], v[74:75], v[60:61] op_sel:[0,1]
    v_pk_mul_f32 v[76:77], v[76:77], v[60:61] op_sel:[0,1]
    v_pk_mul_f32 v[78:79], v[78:79], v[60:61] op_sel:[0,1]
    v_pk_mul_f32 v[80:81], v[80:81], v[62:63] op_sel_hi:[1,0]
    v_pk_mul_f32 v[82:83], v[82:83], v[62:63] op_sel_hi:[1,0]
    v_pk_mul_f32 v[84:85], v[84:85], v[62:63] op_sel_hi:[1,0]
    v_pk_mul_f32 v[86:87], v[86:87], v[62:63] op_sel_hi:[1,0]
    v_pk_mul_f32 v[88:89], v[88:89], v[62:63] op_sel:[0,1]
    v_pk_mul_f32 v[90:91], v[90:91], v[62:63] op_sel:[0,1]
    v_pk_mul_f32 v[92:93], v[92:93], v[62:63] op_sel:[0,1]
    v_pk_mul_f32 v[94:95], v[94:95], v[62:63] op_sel:[0,1]
    v_cvt_pk_bf16_f32 v112, v64, v65
    v_cvt_pk_bf16_f32 v113, v66, v67
    v_cvt_pk_bf16_f32 v114, v68, v69
    v_cvt_pk_bf16_f32 v115, v70, v71
    v_cvt_pk_bf16_f32 v116, v72, v73
    v_cvt_pk_bf16_f32 v117, v74, v75
    v_cvt_pk_bf16_f32 v118, v76, v77
    v_cvt_pk_bf16_f32 v119, v78, v79
    v_cvt_pk_bf16_f32 v120, v80, v81
    v_cvt_pk_bf16_f32 v121, v82, v83
    v_cvt_pk_bf16_f32 v122, v84, v85
    v_cvt_pk_bf16_f32 v123, v86, v87
    v_cvt_pk_bf16_f32 v124, v88, v89
    v_cvt_pk_bf16_f32 v125, v90, v91
    v_cvt_pk_bf16_f32 v126, v92, v93
    v_cvt_pk_bf16_f32 v127, v94, v95
    s_setprio 2
    s_mov_b32 s82, 0x00003f80
    s_mov_b32 s83, 0x3f800000
    s_mov_b32 s10, 0xffff
    v_mov_b32 v32, 0
    v_mov_b32 v33, 0
    v_mov_b32 v34, 0
    v_mov_b32 v35, 0
    v_mov_b32 v36, 0
    v_mov_b32 v37, 0
    s_cmp_eq_u32 s74, 1
    s_cbranch_scc1 Lz_26
    s_cmp_eq_u32 s74, 0
    s_cbranch_scc1 Lacc_28
    buffer_load_dwordx4 v[128:131], v2, s[44:47], s4 offen offset:0 sc1
    buffer_load_dwordx4 v[132:135], v2, s[44:47], s4 offen offset:1024 sc1
    buffer_load_dwordx4 v[136:139], v2, s[44:47], s4 offen offset:2048 sc1
    buffer_load_dwordx4 v[140:143], v2, s[44:47], s4 offen offset:3072 sc1
    buffer_load_dwordx4 v[144:147], v2, s[44:47], s5 offen offset:0 sc1
    buffer_load_dwordx4 v[148:151], v2, s[44:47], s5 offen offset:1024 sc1
    buffer_load_dwordx4 v[152:155], v2, s[44:47], s5 offen offset:2048 sc1
    buffer_load_dwordx4 v[156:159], v2, s[44:47], s5 offen offset:3072 sc1
    buffer_load_dwordx4 v[160:163], v2, s[44:47], s6 offen offset:0 sc1
    buffer_load_dwordx4 v[164:167], v2, s[44:47], s6 offen offset:1024 sc1
    buffer_load_dwordx4 v[168:171], v2, s[44:47], s6 offen offset:2048 sc1
    buffer_load_dwordx4 v[172:175], v2, s[44:47], s6 offen offset:3072 sc1
    buffer_load_dwordx4 v[176:179], v2, s[44:47], s7 offen offset:0 sc1
    buffer_load_dwordx4 v[180:183], v2, s[44:47], s7 offen offset:1024 sc1
    buffer_load_dwordx4 v[184:187], v2, s[44:47], s7 offen offset:2048 sc1
    buffer_load_dwordx4 v[188:191], v2, s[44:47], s7 offen offset:3072 sc1
Lacc_28:
    s_bitcmp1_b32 s10, 0
    s_cbranch_scc0 Lsk_30
    s_waitcnt vmcnt(15)
    v_cmp_ne_u32 vcc, s75, v131
    s_cbranch_vccnz Lsk_30
    v_dot2c_f32_bf16 v32, s82, v128
    v_dot2c_f32_bf16 v33, s83, v128
    v_dot2c_f32_bf16 v34, s82, v129
    v_dot2c_f32_bf16 v35, s83, v129
    v_dot2c_f32_bf16 v36, s82, v130
    v_dot2c_f32_bf16 v37, s83, v130
    s_bitset0_b32 s10, 0
Lsk_30:
    s_bitcmp1_b32 s10, 1
    s_cbranch_scc0 Lsk_31
    s_waitcnt vmcnt(14)
    v_cmp_ne_u32 vcc, s75, v135
    s_cbranch_vccnz Lsk_31
    v_dot2c_f32_bf16 v32, s82, v132
    v_dot2c_f32_bf16 v33, s83, v132
    v_dot2c_f32_bf16 v34, s82, v133
    v_dot2c_f32_bf16 v35, s83, v133
    v_dot2c_f32_bf16 v36, s82, v134
    v_dot2c_f32_bf16 v37, s83, v134
    s_bitset0_b32 s10, 1
Lsk_31:
    s_bitcmp1_b32 s10, 2
    s_cbranch_scc0 Lsk_32
    s_waitcnt vmcnt(13)
    v_cmp_ne_u32 vcc, s75, v139
    s_cbranch_vccnz Lsk_32
    v_dot2c_f32_bf16 v32, s82, v136
    v_dot2c_f32_bf16 v33, s83, v136
    v_dot2c_f32_bf16 v34, s82, v137
    v_dot2c_f32_bf16 v35, s83, v137
    v_dot2c_f32_bf16 v36, s82, v138
    v_dot2c_f32_bf16 v37, s83, v138
    s_bitset0_b32 s10, 2
Lsk_32:
    s_bitcmp1_b32 s10, 3
    s_cbranch_scc0 Lsk_33
    s_waitcnt vmcnt(12)
    v_cmp_ne_u32 vcc, s75, v143
    s_cbranch_vccnz Lsk_33
    v_dot2c_f32_bf16 v32, s82, v140
    v_dot2c_f32_bf16 v33, s83, v140
    v_dot2c_f32_bf16 v34, s82, v141
    v_dot2c_f32_bf16 v35, s83, v141
    v_dot2c_f32_bf16 v36, s82, v142
    v_dot2c_f32_bf16 v37, s83, v142
    s_bitset0_b32 s10, 3
Lsk_33:
    s_bitcmp1_b32 s10, 4
    s_cbranch_scc0 Lsk_34
    s_waitcnt vmcnt(11)
    v_cmp_ne_u32 vcc, s75, v147
    s_cbranch_vccnz Lsk_34
    v_dot2c_f32_bf16 v32, s82, v144
    v_dot2c_f32_bf16 v33, s83, v144
    v_dot2c_f32_bf16 v34, s82, v145
    v_dot2c_f32_bf16 v35, s83, v145
    v_dot2c_f32_bf16 v36, s82, v146
    v_dot2c_f32_bf16 v37, s83, v146
    s_bitset0_b32 s10, 4
Lsk_34:
    s_bitcmp1_b32 s10, 5
    s_cbranch_scc0 Lsk_35
    s_waitcnt vmcnt(10)
    v_cmp_ne_u32 vcc, s75, v151
    s_cbranch_vccnz Lsk_35
    v_dot2c_f32_bf16 v32, s82, v148
    v_dot2c_f32_bf16 v33, s83, v148
    v_dot2c_f32_bf16 v34, s82, v149
    v_dot2c_f32_bf16 v35, s83, v149
    v_dot2c_f32_bf16 v36, s82, v150
    v_dot2c_f32_bf16 v37, s83, v150
    s_bitset0_b32 s10, 5
Lsk_35:
    s_bitcmp1_b32 s10, 6
    s_cbranch_scc0 Lsk_36
    s_waitcnt vmcnt(9)
    v_cmp_ne_u32 vcc, s75, v155
    s_cbranch_vccnz Lsk_36
    v_dot2c_f32_bf16 v32, s82, v152
    v_dot2c_f32_bf16 v33, s83, v152
    v_dot2c_f32_bf16 v34, s82, v153
    v_dot2c_f32_bf16 v35, s83, v153
    v_dot2c_f32_bf16 v36, s82, v154
    v_dot2c_f32_bf16 v37, s83, v154
    s_bitset0_b32 s10, 6
Lsk_36:
    s_bitcmp1_b32 s10, 7
    s_cbranch_scc0 Lsk_37
    s_waitcnt vmcnt(8)
    v_cmp_ne_u32 vcc, s75, v159
    s_cbranch_vccnz Lsk_37
    v_dot2c_f32_bf16 v32, s82, v156
    v_dot2c_f32_bf16 v33, s83, v156
    v_dot2c_f32_bf16 v34, s82, v157
    v_dot2c_f32_bf16 v35, s83, v157
    v_dot2c_f32_bf16 v36, s82, v158
    v_dot2c_f32_bf16 v37, s83, v158
    s_bitset0_b32 s10, 7
Lsk_37:
    s_bitcmp1_b32 s10, 8
    s_cbranch_scc0 Lsk_38
    s_waitcnt vmcnt(7)
    v_cmp_ne_u32 vcc, s75, v163
    s_cbranch_vccnz Lsk_38
    v_dot2c_f32_bf16 v32, s82, v160
    v_dot2c_f32_bf16 v33, s83, v160
    v_dot2c_f32_bf16 v34, s82, v161
    v_dot2c_f32_bf16 v35, s83, v161
    v_dot2c_f32_bf16 v36, s82, v162
    v_dot2c_f32_bf16 v37, s83, v162
    s_bitset0_b32 s10, 8
Lsk_38:
    s_bitcmp1_b32 s10, 9
    s_cbranch_scc0 Lsk_39
    s_waitcnt vmcnt(6)
    v_cmp_ne_u32 vcc, s75, v167
    s_cbranch_vccnz Lsk_39
    v_dot2c_f32_bf16 v32, s82, v164
    v_dot2c_f32_bf16 v33, s83, v164
    v_dot2c_f32_bf16 v34, s82, v165
    v_dot2c_f32_bf16 v35, s83, v165
    v_dot2c_f32_bf16 v36, s82, v166
    v_dot2c_f32_bf16 v37, s83, v166
    s_bitset0_b32 s10, 9
Lsk_39:
    s_bitcmp1_b32 s10, 10
    s_cbranch_scc0 Lsk_40
    s_waitcnt vmcnt(5)
    v_cmp_ne_u32 vcc, s75, v171
    s_cbranch_vccnz Lsk_40
    v_dot2c_f32_bf16 v32, s82, v168
    v_dot2c_f32_bf16 v33, s83, v168
    v_dot2c_f32_bf16 v34, s82, v169
    v_dot2c_f32_bf16 v35, s83, v169
    v_dot2c_f32_bf16 v36, s82, v170
    v_dot2c_f32_bf16 v37, s83, v170
    s_bitset0_b32 s10, 10
Lsk_40:
    s_bitcmp1_b32 s10, 11
    s_cbranch_scc0 Lsk_41
    s_waitcnt vmcnt(4)
    v_cmp_ne_u32 vcc, s75, v175
    s_cbranch_vccnz Lsk_41
    v_dot2c_f32_bf16 v32, s82, v172
    v_dot2c_f32_bf16 v33, s83, v172
    v_dot2c_f32_bf16 v34, s82, v173
    v_dot2c_f32_bf16 v35, s83, v173
    v_dot2c_f32_bf16 v36, s82, v174
    v_dot2c_f32_bf16 v37, s83, v174
    s_bitset0_b32 s10, 11
Lsk_41:
    s_bitcmp1_b32 s10, 12
    s_cbranch_scc0 Lsk_42
    s_waitcnt vmcnt(3)
    v_cmp_ne_u32 vcc, s75, v179
    s_cbranch_vccnz Lsk_42
    v_dot2c_f32_bf16 v32, s82, v176
    v_dot2c_f32_bf16 v33, s83, v176
    v_dot2c_f32_bf16 v34, s82, v177
    v_dot2c_f32_bf16 v35, s83, v177
    v_dot2c_f32_bf16 v36, s82, v178
    v_dot2c_f32_bf16 v37, s83, v178
    s_bitset0_b32 s10, 12
Lsk_42:
    s_bitcmp1_b32 s10, 13
    s_cbranch_scc0 Lsk_43
    s_waitcnt vmcnt(2)
    v_cmp_ne_u32 vcc, s75, v183
    s_cbranch_vccnz Lsk_43
    v_dot2c_f32_bf16 v32, s82, v180
    v_dot2c_f32_bf16 v33, s83, v180
    v_dot2c_f32_bf16 v34, s82, v181
    v_dot2c_f32_bf16 v35, s83, v181
    v_dot2c_f32_bf16 v36, s82, v182
    v_dot2c_f32_bf16 v37, s83, v182
    s_bitset0_b32 s10, 13
Lsk_43:
    s_bitcmp1_b32 s10, 14
    s_cbranch_scc0 Lsk_44
    s_waitcnt vmcnt(1)
    v_cmp_ne_u32 vcc, s75, v187
    s_cbranch_vccnz Lsk_44
    v_dot2c_f32_bf16 v32, s82, v184
    v_dot2c_f32_bf16 v33, s83, v184
    v_dot2c_f32_bf16 v34, s82, v185
    v_dot2c_f32_bf16 v35, s83, v185
    v_dot2c_f32_bf16 v36, s82, v186
    v_dot2c_f32_bf16 v37, s83, v186
    s_bitset0_b32 s10, 14
Lsk_44:
    s_bitcmp1_b32 s10, 15
    s_cbranch_scc0 Lsk_45
    s_waitcnt vmcnt(0)
    v_cmp_ne_u32 vcc, s75, v191
    s_cbranch_vccnz Lsk_45
    v_dot2c_f32_bf16 v32, s82, v188
    v_dot2c_f32_bf16 v33, s83, v188
    v_dot2c_f32_bf16 v34, s82, v189
    v_dot2c_f32_bf16 v35, s83, v189
    v_dot2c_f32_bf16 v36, s82, v190
    v_dot2c_f32_bf16 v37, s83, v190
    s_bitset0_b32 s10, 15
Lsk_45:
    s_cmp_lg_u32 s10, 0
    s_cbranch_scc1 Lret_29
    v_cvt_pk_bf16_f32 v32, v32, v33
    v_cvt_pk_bf16_f32 v33, v34, v35
    v_cvt_pk_bf16_f32 v34, v36, v37
    ds_write2_b32 v25, v32, v33 offset0:0 offset1:1
    ds_write_b32 v25, v34 offset:8
    s_branch Lgd_27
Lret_29:
    s_bitcmp1_b32 s10, 0
    s_cbranch_scc0 Lsk_46
    buffer_load_dwordx4 v[128:131], v2, s[44:47], s4 offen offset:0 sc1
Lsk_46:
    s_bitcmp1_b32 s10, 1
    s_cbranch_scc0 Lsk_47
    buffer_load_dwordx4 v[132:135], v2, s[44:47], s4 offen offset:1024 sc1
Lsk_47:
    s_bitcmp1_b32 s10, 2
    s_cbranch_scc0 Lsk_48
    buffer_load_dwordx4 v[136:139], v2, s[44:47], s4 offen offset:2048 sc1
Lsk_48:
    s_bitcmp1_b32 s10, 3
    s_cbranch_scc0 Lsk_49
    buffer_load_dwordx4 v[140:143], v2, s[44:47], s4 offen offset:3072 sc1
Lsk_49:
    s_bitcmp1_b32 s10, 4
    s_cbranch_scc0 Lsk_50
    buffer_load_dwordx4 v[144:147], v2, s[44:47], s5 offen offset:0 sc1
Lsk_50:
    s_bitcmp1_b32 s10, 5
    s_cbranch_scc0 Lsk_51
    buffer_load_dwordx4 v[148:151], v2, s[44:47], s5 offen offset:1024 sc1
Lsk_51:
    s_bitcmp1_b32 s10, 6
    s_cbranch_scc0 Lsk_52
    buffer_load_dwordx4 v[152:155], v2, s[44:47], s5 offen offset:2048 sc1
Lsk_52:
    s_bitcmp1_b32 s10, 7
    s_cbranch_scc0 Lsk_53
    buffer_load_dwordx4 v[156:159], v2, s[44:47], s5 offen offset:3072 sc1
Lsk_53:
    s_bitcmp1_b32 s10, 8
    s_cbranch_scc0 Lsk_54
    buffer_load_dwordx4 v[160:163], v2, s[44:47], s6 offen offset:0 sc1
Lsk_54:
    s_bitcmp1_b32 s10, 9
    s_cbranch_scc0 Lsk_55
    buffer_load_dwordx4 v[164:167], v2, s[44:47], s6 offen offset:1024 sc1
Lsk_55:
    s_bitcmp1_b32 s10, 10
    s_cbranch_scc0 Lsk_56
    buffer_load_dwordx4 v[168:171], v2, s[44:47], s6 offen offset:2048 sc1
Lsk_56:
    s_bitcmp1_b32 s10, 11
    s_cbranch_scc0 Lsk_57
    buffer_load_dwordx4 v[172:175], v2, s[44:47], s6 offen offset:3072 sc1
Lsk_57:
    s_bitcmp1_b32 s10, 12
    s_cbranch_scc0 Lsk_58
    buffer_load_dwordx4 v[176:179], v2, s[44:47], s7 offen offset:0 sc1
Lsk_58:
    s_bitcmp1_b32 s10, 13
    s_cbranch_scc0 Lsk_59
    buffer_load_dwordx4 v[180:183], v2, s[44:47], s7 offen offset:1024 sc1
Lsk_59:
    s_bitcmp1_b32 s10, 14
    s_cbranch_scc0 Lsk_60
    buffer_load_dwordx4 v[184:187], v2, s[44:47], s7 offen offset:2048 sc1
Lsk_60:
    s_bitcmp1_b32 s10, 15
    s_cbranch_scc0 Lsk_61
    buffer_load_dwordx4 v[188:191], v2, s[44:47], s7 offen offset:3072 sc1
Lsk_61:
    s_waitcnt vmcnt(0)
    s_sub_u32 s77, s77, 1
    s_cbranch_scc1 L_end
    s_branch Lacc_28
Lz_26:
    s_waitcnt vmcnt(0)
    v_xor_b32 v20, s75, v131
    v_xor_b32 v21, s75, v135
    v_xor_b32 v22, s75, v139
    v_or3_b32 v20, v20, v21, v22
    v_cmp_ne_u32 vcc, 0, v20
    s_cbranch_vccz Lgo_62
    buffer_load_dwordx4 v[128:131], v24, s[44:47], s8 offen offset:0 sc1
    buffer_load_dwordx4 v[132:135], v24, s[44:47], s8 offen offset:16 sc1
    buffer_load_dwordx4 v[136:139], v24, s[44:47], s8 offen offset:32 sc1
    s_sub_u32 s77, s77, 1
    s_cbranch_scc1 L_end
    s_branch Lz_26
Lgo_62:
    v_lshlrev_b32 v32, 16, v128
    v_and_b32 v33, 0xffff0000, v128
    v_lshlrev_b32 v34, 16, v129
    v_and_b32 v35, 0xffff0000, v129
    v_lshlrev_b32 v36, 16, v130
    v_and_b32 v37, 0xffff0000, v130
    v_lshlrev_b32 v38, 16, v132
    v_and_b32 v39, 0xffff0000, v132
    v_lshlrev_b32 v40, 16, v133
    v_and_b32 v41, 0xffff0000, v133
    v_lshlrev_b32 v42, 16, v134
    v_and_b32 v43, 0xffff0000, v134
    v_lshlrev_b32 v44, 16, v136
    v_and_b32 v45, 0xffff0000, v136
    v_lshlrev_b32 v46, 16, v137
    v_and_b32 v47, 0xffff0000, v137
    v_add_f32_dpp v32, v32, v32 row_ror:8 row_mask:0xf bank_mask:0xf
    v_add_f32_dpp v33, v33, v33 row_ror:8 row_mask:0xf bank_mask:0xf
    v_add_f32_dpp v34, v34, v34 row_ror:8 row_mask:0xf bank_mask:0xf
    v_add_f32_dpp v35, v35, v35 row_ror:8 row_mask:0xf bank_mask:0xf
    v_add_f32_dpp v36, v36, v36 row_ror:8 row_mask:0xf bank_mask:0xf
    v_add_f32_dpp v37, v37, v37 row_ror:8 row_mask:0xf bank_mask:0xf
    v_add_f32_dpp v38, v38, v38 row_ror:8 row_mask:0xf bank_mask:0xf
    v_add_f32_dpp v39, v39, v39 row_ror:8 row_mask:0xf bank_mask:0xf
    v_add_f32_dpp v40, v40, v40 row_ror:8 row_mask:0xf bank_mask:0xf
    v_add_f32_dpp v41, v41, v41 row_ror:8 row_mask:0xf bank_mask:0xf
    v_add_f32_dpp v42, v42, v42 row_ror:8 row_mask:0xf bank_mask:0xf
    v_add_f32_dpp v43, v43, v43 row_ror:8 row_mask:0xf bank_mask:0xf
    v_add_f32_dpp v44, v44, v44 row_ror:8 row_mask:0xf bank_mask:0xf
    v_add_f32_dpp v45, v45, v45 row_ror:8 row_mask:0xf bank_mask:0xf
    v_add_f32_dpp v46, v46, v46 row_ror:8 row_mask:0xf bank_mask:0xf
    v_add_f32_dpp v47, v47, v47 row_ror:8 row_mask:0xf bank_mask:0xf
    v_add_f32_dpp v32, v32, v32 row_ror:4 row_mask:0xf bank_mask:0xf
    v_add_f32_dpp v33, v33, v33 row_ror:4 row_mask:0xf bank_mask:0xf
    v_add_f32_dpp v34, v34, v34 row_ror:4 row_mask:0xf bank_mask:0xf
    v_add_f32_dpp v35, v35, v35 row_ror:4 row_mask:0xf bank_mask:0xf
    v_add_f32_dpp v36, v36, v36 row_ror:4 row_mask:0xf bank_mask:0xf
    v_add_f32_dpp v37, v37, v37 row_ror:4 row_mask:0xf bank_mask:0xf
    v_add_f32_dpp v38, v38, v38 row_ror:4 row_mask:0xf bank_mask:0xf
    v_add_f32_dpp v39, v39, v39 row_ror:4 row_mask:0xf bank_mask:0xf
    v_add_f32_dpp v40, v40, v40 row_ror:4 row_mask:0xf bank_mask:0xf
    v_add_f32_dpp v41, v41, v41 row_ror:4 row_mask:0xf bank_mask:0xf
    v_add_f32_dpp v42, v42, v42 row_ror:4 row_mask:0xf bank_mask:0xf
    v_add_f32_dpp v43, v43, v43 row_ror:4 row_mask:0xf bank_mask:0xf
    v_add_f32_dpp v44, v44, v44 row_ror:4 row_mask:0xf bank_mask:0xf
    v_add_f32_dpp v45, v45, v45 row_ror:4 row_mask:0xf bank_mask:0xf
    v_add_f32_dpp v46, v46, v46 row_ror:4 row_mask:0xf bank_mask:0xf
    v_add_f32_dpp v47, v47, v47 row_ror:4 row_mask:0xf bank_mask:0xf
    v_add_f32_dpp v32, v32, v32 row_ror:2 row_mask:0xf bank_mask:0xf
    v_add_f32_dpp v33, v33, v33 row_ror:2 row_mask:0xf bank_mask:0xf
    v_add_f32_dpp v34, v34, v34 row_ror:2 row_mask:0xf bank_mask:0xf
    v_add_f32_dpp v35, v35, v35 row_ror:2 row_mask:0xf bank_mask:0xf
    v_add_f32_dpp v36, v36, v36 row_ror:2 row_mask:0xf bank_mask:0xf
    v_add_f32_dpp v37, v37, v37 row_ror:2 row_mask:0xf bank_mask:0xf
    v_add_f32_dpp v38, v38, v38 row_ror:2 row_mask:0xf bank_mask:0xf
    v_add_f32_dpp v39, v39, v39 row_ror:2 row_mask:0xf bank_mask:0xf
    v_add_f32_dpp v40, v40, v40 row_ror:2 row_mask:0xf bank_mask:0xf
    v_add_f32_dpp v41, v41, v41 row_ror:2 row_mask:0xf bank_mask:0xf
    v_add_f32_dpp v42, v42, v42 row_ror:2 row_mask:0xf bank_mask:0xf
    v_add_f32_dpp v43, v43, v43 row_ror:2 row_mask:0xf bank_mask:0xf
    v_add_f32_dpp v44, v44, v44 row_ror:2 row_mask:0xf bank_mask:0xf
    v_add_f32_dpp v45, v45, v45 row_ror:2 row_mask:0xf bank_mask:0xf
    v_add_f32_dpp v46, v46, v46 row_ror:2 row_mask:0xf bank_mask:0xf
    v_add_f32_dpp v47, v47, v47 row_ror:2 row_mask:0xf bank_mask:0xf
    v_add_f32_dpp v32, v32, v32 row_ror:1 row_mask:0xf bank_mask:0xf
    v_add_f32_dpp v33, v33, v33 row_ror:1 row_mask:0xf bank_mask:0xf
    v_add_f32_dpp v34, v34, v34 row_ror:1 row_mask:0xf bank_mask:0xf
    v_add_f32_dpp v35, v35, v35 row_ror:1 row_mask:0xf bank_mask:0xf
    v_add_f32_dpp v36, v36, v36 row_ror:1 row_mask:0xf bank_mask:0xf
    v_add_f32_dpp v37, v37, v37 row_ror:1 row_mask:0xf bank_mask:0xf
    v_add_f32_dpp v38, v38, v38 row_ror:1 row_mask:0xf bank_mask:0xf
    v_add_f32_dpp v39, v39, v39 row_ror:1 row_mask:0xf bank_mask:0xf
    v_add_f32_dpp v40, v40, v40 row_ror:1 row_mask:0xf bank_mask:0xf
    v_add_f32_dpp v41, v41, v41 row_ror:1 row_mask:0xf bank_mask:0xf
    v_add_f32_dpp v42, v42, v42 row_ror:1 row_mask:0xf bank_mask:0xf
    v_add_f32_dpp v43, v43, v43 row_ror:1 row_mask:0xf bank_mask:0xf
    v_add_f32_dpp v44, v44, v44 row_ror:1 row_mask:0xf bank_mask:0xf
    v_add_f32_dpp v45, v45, v45 row_ror:1 row_mask:0xf bank_mask:0xf
    v_add_f32_dpp v46, v46, v46 row_ror:1 row_mask:0xf bank_mask:0xf
    v_add_f32_dpp v47, v47, v47 row_ror:1 row_mask:0xf bank_mask:0xf
    v_cvt_pk_bf16_f32 v48, v32, v33
    v_cvt_pk_bf16_f32 v49, v34, v35
    v_cvt_pk_bf16_f32 v50, v36, v37
    v_cvt_pk_bf16_f32 v51, v38, v39
    v_cvt_pk_bf16_f32 v52, v40, v41
    v_cvt_pk_bf16_f32 v53, v42, v43
    v_cvt_pk_bf16_f32 v54, v44, v45
    v_cvt_pk_bf16_f32 v55, v46, v47
    ds_write_b128 v25, v[48:51]
    ds_write_b128 v25, v[52:55] offset:16
Lgd_27:
    ds_write_b8 v7, v9 offset:64
    v_and_b32 v25, 16, v1
    v_mul_u32_u24 v25, 192, v25
    v_add_u32 v24, 0x20800, v26
    v_sub_u32 v26, v24, v25
    v_add_u32 v25, v24, v25
    v_mov_b32 v28, s75
    v_mov_b32 v29, 0
Lev_63:
    ds_read_b32 v20, v8 offset:64
    s_waitcnt lgkmcnt(0)
    v_readfirstlane_b32 s98, v20
    s_nop 0
    s_cmp_eq_u32 s98, 0x01010101
    s_cbranch_scc1 Levd_64
    s_sub_u32 s77, s77, 1
    s_cbranch_scc1 L_end
    s_branch Lev_63
Levd_64:
    ds_read_b128 v[32:35], v25
    ds_read_b128 v[36:39], v25 offset:16
    ds_read_b128 v[40:43], v26 offset:3072
    ds_read_b128 v[44:47], v26 offset:3088
    s_waitcnt lgkmcnt(3)
    v_mfma_f32_32x32x16_bf16 v[64:79], v[32:35], v[112:115], 0
    s_waitcnt lgkmcnt(2)
    v_mfma_f32_32x32x16_bf16 v[64:79], v[36:39], v[116:119], v[64:79]
    s_waitcnt lgkmcnt(1)
    v_mfma_f32_32x32x16_bf16 v[80:95], v[40:43], v[120:123], 0
    s_waitcnt lgkmcnt(0)
    v_mfma_f32_32x32x16_bf16 v[80:95], v[44:47], v[124:127], v[80:95]
    s_nop 7
    v_add_f32 v20, 0x358637bd, v72
    v_rcp_f32 v20, v20
    s_nop 0
    v_pk_mul_f32 v[64:65], v[64:65], v[20:21] op_sel_hi:[1,0]
    v_pk_mul_f32 v[66:67], v[66:67], v[20:21] op_sel_hi:[1,0]
    v_pk_mul_f32 v[68:69], v[68:69], v[20:21] op_sel_hi:[1,0]
    v_pk_mul_f32 v[70:71], v[70:71], v[20:21] op_sel_hi:[1,0]
    v_cvt_pk_bf16_f32 v48, v64, v65
    v_cvt_pk_bf16_f32 v49, v66, v67
    v_cvt_pk_bf16_f32 v50, v68, v69
    v_cvt_pk_bf16_f32 v51, v70, v71
    buffer_store_dwordx4 v[48:51], v2, s[44:47], s70 offen sc1
    v_add_f32 v21, 0x358637bd, v80
    v_rcp_f32 v21, v21
    s_nop 0
    v_pk_mul_f32 v[88:89], v[88:89], v[20:21] op_sel:[0,1]
    v_pk_mul_f32 v[90:91], v[90:91], v[20:21] op_sel:[0,1]
    v_pk_mul_f32 v[92:93], v[92:93], v[20:21] op_sel:[0,1]
    v_pk_mul_f32 v[94:95], v[94:95], v[20:21] op_sel:[0,1]
    v_cvt_pk_bf16_f32 v52, v88, v89
    v_cvt_pk_bf16_f32 v53, v90, v91
    v_cvt_pk_bf16_f32 v54, v92, v93
    v_cvt_pk_bf16_f32 v55, v94, v95
    buffer_store_dwordx4 v[52:55], v2, s[44:47], s70 offen offset:1024 sc1
    s_waitcnt vmcnt(0)
    s_cmp_lg_u32 s76, 0
    s_cbranch_scc1 Lsafe_65
    buffer_store_dword v28, v29, s[44:47], s71 offen
Lback_66:
    s_setprio 0
    s_lshl_b32 s3, s12, 7
    s_add_u32 s3, s3, 0x4000
    s_lshl_b32 s4, s12, 15
    s_add_u32 s4, s4, 0x200000
    s_lshl_b32 s10, s12, 15
    s_lshl_b32 s6, s15, 11
    s_add_u32 s10, s10, s6
    s_add_u32 s10, s10, 0x400000
    s_lshl_b32 s11, s12, 7
    s_lshl_b32 s6, s15, 2
    s_add_u32 s11, s11, s6
    s_add_u32 s11, s11, 0x6000
    v_mov_b32 v12, s75
    v_mov_b32 v13, 0
    s_lshl_b32 s9, s12, 7
    s_add_u32 s9, s9, 0x6000
    v_and_b32 v4, 15, v1
    v_lshlrev_b32 v4, 2, v4
    s_mov_b32 s5, s4
    s_getpc_b64 s[6:7]
Lpc_67:
    s_lshl_b32 s8, s73, 2
    s_add_u32 s8, s8, s74
    s_mul_i32 s8, s8, 256
    s_min_u32 s8, s8, L_codeend-L_p3code-256
    s_add_u32 s6, s6, s8
    s_addc_u32 s7, s7, 0
    s_add_u32 s6, s6, L_p3code-Lpc_67
    s_addc_u32 s7, s7, 0
    v_lshlrev_b32 v24, 7, v1
    s_mov_b64 exec, 3
    global_load_dword v24, v24, s[6:7]
    s_mov_b64 exec, -1
    s_waitcnt vmcnt(0)
L_p3code:
    s_lshl_b32 s88, s2, 2
    s_add_u32 s88, s88, s74
    s_mul_i32 s88, s88, 1376
    s_and_b32 s88, s88, 0xffffffc0
    s_add_u32 s90, s30, s88
    s_addc_u32 s91, s31, 0
    s_load_dword s92, s[90:91], 0
    s_load_dword s93, s[90:91], 64
    s_load_dword s94, s[90:91], 128
    s_load_dword s95, s[90:91], 192
    s_load_dword s92, s[90:91], 256
    s_load_dword s93, s[90:91], 320
    s_load_dword s94, s[90:91], 384
    s_load_dword s95, s[90:91], 448
    s_load_dword s92, s[90:91], 512
    s_load_dword s93, s[90:91], 576
    s_load_dword s94, s[90:91], 640
    s_load_dword s95, s[90:91], 704
    s_load_dword s92, s[90:91], 768
    s_load_dword s93, s[90:91], 832
    s_load_dword s94, s[90:91], 896
    s_load_dword s95, s[90:91], 960
    s_load_dword s92, s[90:91], 1024
    s_load_dword s93, s[90:91], 1088
    s_load_dword s94, s[90:91], 1152
    s_load_dword s95, s[90:91], 1216
    s_load_dword s92, s[90:91], 1280
    s_load_dword s93, s[90:91], 1344
Lev_68:
    ds_read_b32 v20, v8 offset:96
    s_waitcnt lgkmcnt(0)
    v_readfirstlane_b32 s98, v20
    s_nop 0
    s_cmp_eq_u32 s98, 0x01010101
    s_cbranch_scc1 Levd_69
    s_cmp_lg_u32 s98, 0
    s_cbranch_scc1 Levs_70
    s_sleep 3
Levs_70:
    s_sleep 1
    s_sub_u32 s77, s77, 1
    s_cbranch_scc1 L_end
    s_branch Lev_68
Levd_69:
    s_cmp_lg_u32 s74, 0
    s_cbranch_scc1 Lgp_71
    buffer_load_dword v22, v11, s[44:47], s3 offen sc1
    s_sleep 2
Lpf_73:
    buffer_load_dword v23, v11, s[44:47], s3 offen sc1
    s_waitcnt vmcnt(1)
    v_cmp_ne_u32 vcc, s75, v22
    s_cbranch_vccz Lpfd_74
    buffer_load_dword v22, v11, s[44:47], s3 offen sc1
    s_waitcnt vmcnt(1)
    v_cmp_ne_u32 vcc, s75, v23
    s_cbranch_vccz Lpfd_74
    s_sub_u32 s77, s77, 1
    s_cbranch_scc1 L_end
    s_branch Lpf_73
Lpfd_74:
    ds_write_b8 v8, v9 offset:560
    s_branch Lgpd_72
Lgp_71:
Lev_75:
    ds_read_u8 v20, v8 offset:560
    s_waitcnt lgkmcnt(0)
    v_cmp_eq_u32 vcc, 0, v20
    s_cbranch_vccz Levd_76
    s_sub_u32 s77, s77, 1
    s_cbranch_scc1 L_end
    s_branch Lev_75
Levd_76:
Lgpd_72:
    s_setprio 2
    buffer_load_dwordx4 v[128:131], v2, s[44:47], s5 offen offset:0 sc1
    buffer_load_dwordx4 v[132:135], v2, s[44:47], s5 offen offset:1024 sc1
    buffer_load_dwordx4 v[136:139], v2, s[44:47], s5 offen offset:2048 sc1
    buffer_load_dwordx4 v[140:143], v2, s[44:47], s5 offen offset:3072 sc1
    s_add_u32 s5, s5, 4096
    buffer_load_dwordx4 v[144:147], v2, s[44:47], s5 offen offset:0 sc1
    buffer_load_dwordx4 v[148:151], v2, s[44:47], s5 offen offset:1024 sc1
    buffer_load_dwordx4 v[152:155], v2, s[44:47], s5 offen offset:2048 sc1
    buffer_load_dwordx4 v[156:159], v2, s[44:47], s5 offen offset:3072 sc1
    s_lshl_b32 s6, s74, 11
    s_add_u32 s6, s6, 0x25800
    v_add_u32 v14, s6, v2
Lev_78:
    ds_read_b32 v20, v8 offset:112
    s_waitcnt lgkmcnt(0)
    v_readfirstlane_b32 s98, v20
    s_nop 0
    s_cmp_eq_u32 s98, 0x01010101
    s_cbranch_scc1 Levd_79
    s_sub_u32 s77, s77, 1
    s_cbranch_scc1 L_end
    s_branch Lev_78
Levd_79:
    ds_read_b64_tr_b16 v[32:33], v3 offset:0
    ds_read_b64_tr_b16 v[34:35], v3 offset:512
    ds_read_b64_tr_b16 v[36:37], v3 offset:32768
    ds_read_b64_tr_b16 v[38:39], v3 offset:33280
    ds_read_b64_tr_b16 v[40:41], v3 offset:1024
    ds_read_b64_tr_b16 v[42:43], v3 offset:1536
    ds_read_b64_tr_b16 v[44:45], v3 offset:33792
    ds_read_b64_tr_b16 v[46:47], v3 offset:34304
    ds_read_b64_tr_b16 v[48:49], v3 offset:2048
    ds_read_b64_tr_b16 v[50:51], v3 offset:2560
    ds_read_b64_tr_b16 v[52:53], v3 offset:34816
    ds_read_b64_tr_b16 v[54:55], v3 offset:35328
    s_waitcnt vmcnt(7)
    s_waitcnt lgkmcnt(10)
    v_mfma_f32_32x32x16_bf16 v[64:79], v[32:35], v[128:131], 0
    ds_read_b64_tr_b16 v[56:57], v3 offset:3072
    ds_read_b64_tr_b16 v[58:59], v3 offset:3584
    s_add_u32 s5, s5, 4096
    buffer_load_dwordx4 v[160:163], v2, s[44:47], s5 offen offset:0 sc1
    s_waitcnt lgkmcnt(10)
    v_mfma_f32_32x32x16_bf16 v[80:95], v[36:39], v[128:131], 0
    ds_read_b64_tr_b16 v[60:61], v3 offset:35840
    ds_read_b64_tr_b16 v[62:63], v3 offset:36352
    s_waitcnt vmcnt(7)
    s_waitcnt lgkmcnt(10)
    v_mfma_f32_32x32x16_bf16 v[64:79], v[40:43], v[132:135], v[64:79]
    ds_read_b64_tr_b16 v[32:33], v3 offset:4096
    ds_read_b64_tr_b16 v[34:35], v3 offset:4608
    buffer_load_dwordx4 v[164:167], v2, s[44:47], s5 offen offset:1024 sc1
    s_waitcnt lgkmcnt(10)
    v_mfma_f32_32x32x16_bf16 v[80:95], v[44:47], v[132:135], v[80:95]
    ds_read_b64_tr_b16 v[36:37], v3 offset:36864
    ds_read_b64_tr_b16 v[38:39], v3 offset:37376
    s_waitcnt vmcnt(7)
    s_waitcnt lgkmcnt(10)
    v_mfma_f32_32x32x16_bf16 v[64:79], v[48:51], v[136:139], v[64:79]
    ds_read_b64_tr_b16 v[40:41], v3 offset:5120
    ds_read_b64_tr_b16 v[42:43], v3 offset:5632
    buffer_load_dwordx4 v[168:171], v2, s[44:47], s5 offen offset:2048 sc1
    s_waitcnt lgkmcnt(10)
    v_mfma_f32_32x32x16_bf16 v[80:95], v[52:55], v[136:139], v[80:95]
    ds_read_b64_tr_b16 v[44:45], v3 offset:37888
    ds_read_b64_tr_b16 v[46:47], v3 offset:38400
    s_waitcnt vmcnt(7)
    s_waitcnt lgkmcnt(10)
    v_mfma_f32_32x32x16_bf16 v[64:79], v[56:59], v[140:143], v[64:79]
    ds_read_b64_tr_b16 v[48:49], v3 offset:6144
    ds_read_b64_tr_b16 v[50:51], v3 offset:6656
    buffer_load_dwordx4 v[172:175], v2, s[44:47], s5 offen offset:3072 sc1
    s_waitcnt lgkmcnt(10)
    v_mfma_f32_32x32x16_bf16 v[80:95], v[60:63], v[140:143], v[80:95]
    ds_read_b64_tr_b16 v[52:53], v3 offset:38912
    ds_read_b64_tr_b16 v[54:55], v3 offset:39424
    s_waitcnt vmcnt(7)
    s_waitcnt lgkmcnt(10)
    v_mfma_f32_32x32x16_bf16 v[64:79], v[32:35], v[144:147], v[64:79]
    ds_read_b64_tr_b16 v[56:57], v3 offset:7168
    ds_read_b64_tr_b16 v[58:59], v3 offset:7680
    s_add_u32 s5, s5, 4096
    buffer_load_dwordx4 v[176:179], v2, s[44:47], s5 offen offset:0 sc1
    s_waitcnt lgkmcnt(10)
    v_mfma_f32_32x32x16_bf16 v[80:95], v[36:39], v[144:147], v[80:95]
    ds_read_b64_tr_b16 v[60:61], v3 offset:39936
    ds_read_b64_tr_b16 v[62:63], v3 offset:40448
    ds_write_b8 v7, v9 offset:256
    s_waitcnt vmcnt(7)
    s_waitcnt lgkmcnt(11)
    v_mfma_f32_32x32x16_bf16 v[64:79], v[40:43], v[148:151], v[64:79]
    ds_read_b64_tr_b16 v[32:33], v3 offset:8192
    ds_read_b64_tr_b16 v[34:35], v3 offset:8704
    buffer_load_dwordx4 v[180:183], v2, s[44:47], s5 offen offset:1024 sc1
    s_waitcnt lgkmcnt(11)
    v_mfma_f32_32x32x16_bf16 v[80:95], v[44:47], v[148:151], v[80:95]
    ds_read_b64_tr_b16 v[36:37], v3 offset:40960
    ds_read_b64_tr_b16 v[38:39], v3 offset:41472
    s_waitcnt vmcnt(7)
    s_waitcnt lgkmcnt(11)
    v_mfma_f32_32x32x16_bf16 v[64:79], v[48:51], v[152:155], v[64:79]
    ds_read_b64_tr_b16 v[40:41], v3 offset:9216
    ds_read_b64_tr_b16 v[42:43], v3 offset:9728
    buffer_load_dwordx4 v[184:187], v2, s[44:47], s5 offen offset:2048 sc1
    s_waitcnt lgkmcnt(11)
    v_mfma_f32_32x32x16_bf16 v[80:95], v[52:55], v[152:155], v[80:95]
    ds_read_b64_tr_b16 v[44:45], v3 offset:41984
    ds_read_b64_tr_b16 v[46:47], v3 offset:42496
    s_waitcnt vmcnt(7)
    s_waitcnt lgkmcnt(11)
    v_mfma_f32_32x32x16_bf16 v[64:79], v[56:59], v[156:159], v[64:79]
    ds_read_b64_tr_b16 v[48:49], v3 offset:10240
    ds_read_b64_tr_b16 v[50:51], v3 offset:10752
    buffer_load_dwordx4 v[188:191], v2, s[44:47], s5 offen offset:3072 sc1
    s_waitcnt lgkmcnt(11)
    v_mfma_f32_32x32x16_bf16 v[80:95], v[60:63], v[156:159], v[80:95]
    ds_read_b64_tr_b16 v[52:53], v3 offset:43008
    ds_read_b64_tr_b16 v[54:55], v3 offset:43520
    s_waitcnt vmcnt(7)
    s_waitcnt lgkmcnt(10)
    v_mfma_f32_32x32x16_bf16 v[64:79], v[32:35], v[160:163], v[64:79]
    ds_read_b64_tr_b16 v[56:57], v3 offset:11264
    ds_read_b64_tr_b16 v[58:59], v3 offset:11776
    s_add_u32 s5, s5, 4096
    buffer_load_dwordx4 v[192:195], v2, s[44:47], s5 offen offset:0 sc1
    s_waitcnt lgkmcnt(10)
    v_mfma_f32_32x32x16_bf16 v[80:95], v[36:39], v[160:163], v[80:95]
    ds_read_b64_tr_b16 v[60:61], v3 offset:44032
    ds_read_b64_tr_b16 v[62:63], v3 offset:44544
    s_waitcnt vmcnt(7)
    s_waitcnt lgkmcnt(10)
    v_mfma_f32_32x32x16_bf16 v[64:79], v[40:43], v[164:167], v[64:79]
    ds_read_b64_tr_b16 v[32:33], v3 offset:12288
    ds_read_b64_tr_b16 v[34:35], v3 offset:12800
    buffer_load_dwordx4 v[196:199], v2, s[44:47], s5 offen offset:1024 sc1
    s_waitcnt lgkmcnt(10)
    v_mfma_f32_32x32x16_bf16 v[80:95], v[44:47], v[164:167], v[80:95]
    ds_read_b64_tr_b16 v[36:37], v3 offset:45056
    ds_read_b64_tr_b16 v[38:39], v3 offset:45568
    s_waitcnt vmcnt(7)
    s_waitcnt lgkmcnt(10)
    v_mfma_f32_32x32x16_bf16 v[64:79], v[48:51], v[168:171], v[64:79]
    ds_read_b64_tr_b16 v[40:41], v3 offset:13312
    ds_read_b64_tr_b16 v[42:43], v3 offset:13824
    buffer_load_dwordx4 v[200:203], v2, s[44:47], s5 offen offset:2048 sc1
    s_waitcnt lgkmcnt(10)
    v_mfma_f32_32x32x16_bf16 v[80:95], v[52:55], v[168:171], v[80:95]
    ds_read_b64_tr_b16 v[44:45], v3 offset:46080
    ds_read_b64_tr_b16 v[46:47], v3 offset:46592
    s_waitcnt vmcnt(7)
    s_waitcnt lgkmcnt(10)
    v_mfma_f32_32x32x16_bf16 v[64:79], v[56:59], v[172:175], v[64:79]
    ds_read_b64_tr_b16 v[48:49], v3 offset:14336
    ds_read_b64_tr_b16 v[50:51], v3 offset:14848
    buffer_load_dwordx4 v[204:207], v2, s[44:47], s5 offen offset:3072 sc1
    s_waitcnt lgkmcnt(10)
    v_mfma_f32_32x32x16_bf16 v[80:95], v[60:63], v[172:175], v[80:95]
    ds_read_b64_tr_b16 v[52:53], v3 offset:47104
    ds_read_b64_tr_b16 v[54:55], v3 offset:47616
    s_waitcnt vmcnt(7)
    s_waitcnt lgkmcnt(10)
    v_mfma_f32_32x32x16_bf16 v[64:79], v[32:35], v[176:179], v[64:79]
    ds_read_b64_tr_b16 v[56:57], v3 offset:15360
    ds_read_b64_tr_b16 v[58:59], v3 offset:15872
    s_add_u32 s5, s5, 4096
    buffer_load_dwordx4 v[208:211], v2, s[44:47], s5 offen offset:0 sc1
    s_waitcnt lgkmcnt(10)
    v_mfma_f32_32x32x16_bf16 v[80:95], v[36:39], v[176:179], v[80:95]
    ds_read_b64_tr_b16 v[60:61], v3 offset:48128
    ds_read_b64_tr_b16 v[62:63], v3 offset:48640
    ds_write_b8 v7, v9 offset:272
    s_waitcnt vmcnt(7)
    s_waitcnt lgkmcnt(11)
    v_mfma_f32_32x32x16_bf16 v[64:79], v[40:43], v[180:183], v[64:79]
    ds_read_b64_tr_b16 v[32:33], v3 offset:16384
    ds_read_b64_tr_b16 v[34:35], v3 offset:16896
    buffer_load_dwordx4 v[212:215], v2, s[44:47], s5 offen offset:1024 sc1
    s_waitcnt lgkmcnt(11)
    v_mfma_f32_32x32x16_bf16 v[80:95], v[44:47], v[180:183], v[80:95]
    ds_read_b64_tr_b16 v[36:37], v3 offset:49152
    ds_read_b64_tr_b16 v[38:39], v3 offset:49664
    s_waitcnt vmcnt(7)
    s_waitcnt lgkmcnt(11)
    v_mfma_f32_32x32x16_bf16 v[64:79], v[48:51], v[184:187], v[64:79]
    ds_read_b64_tr_b16 v[40:41], v3 offset:17408
    ds_read_b64_tr_b16 v[42:43], v3 offset:17920
    buffer_load_dwordx4 v[216:219], v2, s[44:47], s5 offen offset:2048 sc1
    s_waitcnt lgkmcnt(11)
    v_mfma_f32_32x32x16_bf16 v[80:95], v[52:55], v[184:187], v[80:95]
    ds_read_b64_tr_b16 v[44:45], v3 offset:50176
    ds_read_b64_tr_b16 v[46:47], v3 offset:50688
    s_waitcnt vmcnt(7)
    s_waitcnt lgkmcnt(11)
    v_mfma_f32_32x32x16_bf16 v[64:79], v[56:59], v[188:191], v[64:79]
    ds_read_b64_tr_b16 v[48:49], v3 offset:18432
    ds_read_b64_tr_b16 v[50:51], v3 offset:18944
    buffer_load_dwordx4 v[220:223], v2, s[44:47], s5 offen offset:3072 sc1
    s_waitcnt lgkmcnt(11)
    v_mfma_f32_32x32x16_bf16 v[80:95], v[60:63], v[188:191], v[80:95]
    ds_read_b64_tr_b16 v[52:53], v3 offset:51200
    ds_read_b64_tr_b16 v[54:55], v3 offset:51712
    s_waitcnt vmcnt(7)
    s_waitcnt lgkmcnt(10)
    v_mfma_f32_32x32x16_bf16 v[64:79], v[32:35], v[192:195], v[64:79]
    ds_read_b64_tr_b16 v[56:57], v3 offset:19456
    ds_read_b64_tr_b16 v[58:59], v3 offset:19968
    s_add_u32 s5, s5, 4096
    buffer_load_dwordx4 v[224:227], v2, s[44:47], s5 offen offset:0 sc1
    s_waitcnt lgkmcnt(10)
    v_mfma_f32_32x32x16_bf16 v[80:95], v[36:39], v[192:195], v[80:95]
    ds_read_b64_tr_b16 v[60:61], v3 offset:52224
    ds_read_b64_tr_b16 v[62:63], v3 offset:52736
    s_waitcnt vmcnt(7)
    s_waitcnt lgkmcnt(10)
    v_mfma_f32_32x32x16_bf16 v[64:79], v[40:43], v[196:199], v[64:79]
    ds_read_b64_tr_b16 v[32:33], v3 offset:20480
    ds_read_b64_tr_b16 v[34:35], v3 offset:20992
    buffer_load_dwordx4 v[228:231], v2, s[44:47], s5 offen offset:1024 sc1
    s_waitcnt lgkmcnt(10)
    v_mfma_f32_32x32x16_bf16 v[80:95], v[44:47], v[196:199], v[80:95]
    ds_read_b64_tr_b16 v[36:37], v3 offset:53248
    ds_read_b64_tr_b16 v[38:39], v3 offset:53760
    s_waitcnt vmcnt(7)
    s_waitcnt lgkmcnt(10)
    v_mfma_f32_32x32x16_bf16 v[64:79], v[48:51], v[200:203], v[64:79]
    ds_read_b64_tr_b16 v[40:41], v3 offset:21504
    ds_read_b64_tr_b16 v[42:43], v3 offset:22016
    buffer_load_dwordx4 v[232:235], v2, s[44:47], s5 offen offset:2048 sc1
    s_waitcnt lgkmcnt(10)
    v_mfma_f32_32x32x16_bf16 v[80:95], v[52:55], v[200:203], v[80:95]
    ds_read_b64_tr_b16 v[44:45], v3 offset:54272
    ds_read_b64_tr_b16 v[46:47], v3 offset:54784
    s_waitcnt vmcnt(7)
    s_waitcnt lgkmcnt(10)
    v_mfma_f32_32x32x16_bf16 v[64:79], v[56:59], v[204:207], v[64:79]
    ds_read_b64_tr_b16 v[48:49], v3 offset:22528
    ds_read_b64_tr_b16 v[50:51], v3 offset:23040
    buffer_load_dwordx4 v[236:239], v2, s[44:47], s5 offen offset:3072 sc1
    s_waitcnt lgkmcnt(10)
    v_mfma_f32_32x32x16_bf16 v[80:95], v[60:63], v[204:207], v[80:95]
    ds_read_b64_tr_b16 v[52:53], v3 offset:55296
    ds_read_b64_tr_b16 v[54:55], v3 offset:55808
    s_waitcnt vmcnt(7)
    s_waitcnt lgkmcnt(10)
    v_mfma_f32_32x32x16_bf16 v[64:79], v[32:35], v[208:211], v[64:79]
    ds_read_b64_tr_b16 v[56:57], v3 offset:23552
    ds_read_b64_tr_b16 v[58:59], v3 offset:24064
    s_add_u32 s5, s5, 4096
    buffer_load_dwordx4 v[240:243], v2, s[44:47], s5 offen offset:0 sc1
    s_waitcnt lgkmcnt(10)
    v_mfma_f32_32x32x16_bf16 v[80:95], v[36:39], v[208:211], v[80:95]
    ds_read_b64_tr_b16 v[60:61], v3 offset:56320
    ds_read_b64_tr_b16 v[62:63], v3 offset:56832
    ds_write_b8 v7, v9 offset:288
    s_waitcnt vmcnt(7)
    s_waitcnt lgkmcnt(11)
    v_mfma_f32_32x32x16_bf16 v[64:79], v[40:43], v[212:215], v[64:79]
    ds_read_b64_tr_b16 v[32:33], v3 offset:24576
    ds_read_b64_tr_b16 v[34:35], v3 offset:25088
    buffer_load_dwordx4 v[244:247], v2, s[44:47], s5 offen offset:1024 sc1
    s_waitcnt lgkmcnt(11)
    v_mfma_f32_32x32x16_bf16 v[80:95], v[44:47], v[212:215], v[80:95]
    ds_read_b64_tr_b16 v[36:37], v3 offset:57344
    ds_read_b64_tr_b16 v[38:39], v3 offset:57856
    s_waitcnt vmcnt(7)
    s_waitcnt lgkmcnt(11)
    v_mfma_f32_32x32x16_bf16 v[64:79], v[48:51], v[216:219], v[64:79]
    ds_read_b64_tr_b16 v[40:41], v3 offset:25600
    ds_read_b64_tr_b16 v[42:43], v3 offset:26112
    buffer_load_dwordx4 v[248:251], v2, s[44:47], s5 offen offset:2048 sc1
    s_waitcnt lgkmcnt(11)
    v_mfma_f32_32x32x16_bf16 v[80:95], v[52:55], v[216:219], v[80:95]
    ds_read_b64_tr_b16 v[44:45], v3 offset:58368
    ds_read_b64_tr_b16 v[46:47], v3 offset:58880
    s_waitcnt vmcnt(7)
    s_waitcnt lgkmcnt(11)
    v_mfma_f32_32x32x16_bf16 v[64:79], v[56:59], v[220:223], v[64:79]
    ds_read_b64_tr_b16 v[48:49], v3 offset:26624
    ds_read_b64_tr_b16 v[50:51], v3 offset:27136
    buffer_load_dwordx4 v[252:255], v2, s[44:47], s5 offen offset:3072 sc1
    ds_write_b8 v7, v9 offset:480
    s_waitcnt lgkmcnt(12)
    v_mfma_f32_32x32x16_bf16 v[80:95], v[60:63], v[220:223], v[80:95]
    ds_read_b64_tr_b16 v[52:53], v3 offset:59392
    ds_read_b64_tr_b16 v[54:55], v3 offset:59904
    s_waitcnt vmcnt(7)
    s_waitcnt lgkmcnt(11)
    v_mfma_f32_32x32x16_bf16 v[64:79], v[32:35], v[224:227], v[64:79]
    ds_read_b64_tr_b16 v[56:57], v3 offset:27648
    ds_read_b64_tr_b16 v[58:59], v3 offset:28160
    s_waitcnt lgkmcnt(11)
    v_mfma_f32_32x32x16_bf16 v[80:95], v[36:39], v[224:227], v[80:95]
    ds_read_b64_tr_b16 v[60:61], v3 offset:60416
    ds_read_b64_tr_b16 v[62:63], v3 offset:60928
    s_waitcnt vmcnt(6)
    s_waitcnt lgkmcnt(11)
    v_mfma_f32_32x32x16_bf16 v[64:79], v[40:43], v[228:231], v[64:79]
    ds_read_b64_tr_b16 v[32:33], v3 offset:28672
    ds_read_b64_tr_b16 v[34:35], v3 offset:29184
    s_waitcnt lgkmcnt(11)
    v_mfma_f32_32x32x16_bf16 v[80:95], v[44:47], v[228:231], v[80:95]
    ds_read_b64_tr_b16 v[36:37], v3 offset:61440
    ds_read_b64_tr_b16 v[38:39], v3 offset:61952
    s_waitcnt vmcnt(5)
    s_waitcnt lgkmcnt(11)
    v_mfma_f32_32x32x16_bf16 v[64:79], v[48:51], v[232:235], v[64:79]
    ds_read_b64_tr_b16 v[40:41], v3 offset:29696
    ds_read_b64_tr_b16 v[42:43], v3 offset:30208
    s_waitcnt lgkmcnt(10)
    v_mfma_f32_32x32x16_bf16 v[80:95], v[52:55], v[232:235], v[80:95]
    ds_read_b64_tr_b16 v[44:45], v3 offset:62464
    ds_read_b64_tr_b16 v[46:47], v3 offset:62976
    ds_read_b32 v20, v8 offset:576
    s_waitcnt vmcnt(4)
    s_waitcnt lgkmcnt(11)
    v_mfma_f32_32x32x16_bf16 v[64:79], v[56:59], v[236:239], v[64:79]
    ds_read_b64_tr_b16 v[48:49], v3 offset:30720
    ds_read_b64_tr_b16 v[50:51], v3 offset:31232
    s_waitcnt lgkmcnt(11)
    v_mfma_f32_32x32x16_bf16 v[80:95], v[60:63], v[236:239], v[80:95]
    ds_read_b64_tr_b16 v[52:53], v3 offset:63488
    ds_read_b64_tr_b16 v[54:55], v3 offset:64000
    s_waitcnt vmcnt(3)
    s_waitcnt lgkmcnt(11)
    v_mfma_f32_32x32x16_bf16 v[64:79], v[32:35], v[240:243], v[64:79]
    ds_read_b64_tr_b16 v[56:57], v3 offset:31744
    ds_read_b64_tr_b16 v[58:59], v3 offset:32256
    s_waitcnt lgkmcnt(11)
    v_mfma_f32_32x32x16_bf16 v[80:95], v[36:39], v[240:243], v[80:95]
    ds_read_b64_tr_b16 v[60:61], v3 offset:64512
    ds_read_b64_tr_b16 v[62:63], v3 offset:65024
    ds_write_b8 v7, v9 offset:304
    s_waitcnt vmcnt(2)
    s_waitcnt lgkmcnt(12)
    v_mfma_f32_32x32x16_bf16 v[64:79], v[40:43], v[244:247], v[64:79]
    s_waitcnt lgkmcnt(9)
    v_cmp_ne_u32 vcc, 0x01010101, v20
    s_cbranch_vccnz Lspin_80
Lspinb_81:
    ds_read_b64_tr_b16 v[32:33], v5 offset:0
    ds_read_b64_tr_b16 v[34:35], v5 offset:512
    v_mfma_f32_32x32x16_bf16 v[80:95], v[44:47], v[244:247], v[80:95]
    ds_read_b64_tr_b16 v[36:37], v5 offset:32768
    ds_read_b64_tr_b16 v[38:39], v5 offset:33280
    s_waitcnt vmcnt(1)
    s_waitcnt lgkmcnt(11)
    v_mfma_f32_32x32x16_bf16 v[64:79], v[48:51], v[248:251], v[64:79]
    ds_read_b64_tr_b16 v[40:41], v5 offset:1024
    ds_read_b64_tr_b16 v[42:43], v5 offset:1536
    s_waitcnt lgkmcnt(11)
    v_mfma_f32_32x32x16_bf16 v[80:95], v[52:55], v[248:251], v[80:95]
    ds_read_b64_tr_b16 v[44:45], v5 offset:33792
    ds_read_b64_tr_b16 v[46:47], v5 offset:34304
    s_waitcnt vmcnt(0)
    s_waitcnt lgkmcnt(11)
    v_mfma_f32_32x32x16_bf16 v[64:79], v[56:59], v[252:255], v[64:79]
    ds_read_b64_tr_b16 v[48:49], v5 offset:2048
    ds_read_b64_tr_b16 v[50:51], v5 offset:2560
    s_waitcnt lgkmcnt(11)
    v_mfma_f32_32x32x16_bf16 v[80:95], v[60:63], v[252:255], v[80:95]
    ds_read_b64_tr_b16 v[52:53], v5 offset:34816
    ds_read_b64_tr_b16 v[54:55], v5 offset:35328
    s_waitcnt lgkmcnt(10)
    v_mfma_f32_32x32x16_bf16 v[96:111], v[32:35], v[128:131], 0
    ds_read_b64_tr_b16 v[56:57], v5 offset:3072
    ds_read_b64_tr_b16 v[58:59], v5 offset:3584
    s_waitcnt lgkmcnt(10)
    v_mfma_f32_32x32x16_bf16 v[112:127], v[36:39], v[128:131], 0
    ds_read_b64_tr_b16 v[60:61], v5 offset:35840
    ds_read_b64_tr_b16 v[62:63], v5 offset:36352
    s_waitcnt lgkmcnt(10)
    v_mfma_f32_32x32x16_bf16 v[96:111], v[40:43], v[132:135], v[96:111]
    ds_read_b64_tr_b16 v[32:33], v5 offset:4096
    ds_read_b64_tr_b16 v[34:35], v5 offset:4608
    v_max_f32 v64, 0, v64
    v_max_f32 v65, 0, v65
    v_mul_f32 v64, v64, v80
    v_mul_f32 v65, v65, v81
    s_waitcnt lgkmcnt(10)
    v_mfma_f32_32x32x16_bf16 v[112:127], v[44:47], v[132:135], v[112:127]
    ds_read_b64_tr_b16 v[36:37], v5 offset:36864
    ds_read_b64_tr_b16 v[38:39], v5 offset:37376
    v_cvt_pk_bf16_f32 v24, v64, v65
    v_max_f32 v66, 0, v66
    v_max_f32 v67, 0, v67
    v_mul_f32 v66, v66, v82
    s_waitcnt lgkmcnt(10)
    v_mfma_f32_32x32x16_bf16 v[96:111], v[48:51], v[136:139], v[96:111]
    ds_read_b64_tr_b16 v[40:41], v5 offset:5120
    ds_read_b64_tr_b16 v[42:43], v5 offset:5632
    v_mul_f32 v67, v67, v83
    v_cvt_pk_bf16_f32 v25, v66, v67
    v_max_f32 v68, 0, v68
    v_max_f32 v69, 0, v69
    s_waitcnt lgkmcnt(10)
    v_mfma_f32_32x32x16_bf16 v[112:127], v[52:55], v[136:139], v[112:127]
    ds_read_b64_tr_b16 v[44:45], v5 offset:37888
    ds_read_b64_tr_b16 v[46:47], v5 offset:38400
    v_mul_f32 v68, v68, v84
    v_mul_f32 v69, v69, v85
    v_cvt_pk_bf16_f32 v26, v68, v69
    v_max_f32 v70, 0, v70
    s_waitcnt lgkmcnt(10)
    v_mfma_f32_32x32x16_bf16 v[96:111], v[56:59], v[140:143], v[96:111]
    ds_read_b64_tr_b16 v[48:49], v5 offset:6144
    ds_read_b64_tr_b16 v[50:51], v5 offset:6656
    v_max_f32 v71, 0, v71
    v_mul_f32 v70, v70, v86
    v_mul_f32 v71, v71, v87
    v_cvt_pk_bf16_f32 v27, v70, v71
    s_waitcnt lgkmcnt(10)
    v_mfma_f32_32x32x16_bf16 v[112:127], v[60:63], v[140:143], v[112:127]
    ds_read_b64_tr_b16 v[52:53], v5 offset:38912
    ds_read_b64_tr_b16 v[54:55], v5 offset:39424
    v_max_f32 v72, 0, v72
    v_max_f32 v73, 0, v73
    v_mul_f32 v72, v72, v88
    v_mul_f32 v73, v73, v89
    s_waitcnt lgkmcnt(10)
    v_mfma_f32_32x32x16_bf16 v[96:111], v[32:35], v[144:147], v[96:111]
    ds_read_b64_tr_b16 v[56:57], v5 offset:7168
    ds_read_b64_tr_b16 v[58:59], v5 offset:7680
    v_cvt_pk_bf16_f32 v28, v72, v73
    v_max_f32 v74, 0, v74
    v_max_f32 v75, 0, v75
    v_mul_f32 v74, v74, v90
    s_waitcnt lgkmcnt(10)
    v_mfma_f32_32x32x16_bf16 v[112:127], v[36:39], v[144:147], v[112:127]
    ds_read_b64_tr_b16 v[60:61], v5 offset:39936
    ds_read_b64_tr_b16 v[62:63], v5 offset:40448
    ds_write_b8 v7, v9 offset:320
    v_mul_f32 v75, v75, v91
    v_cvt_pk_bf16_f32 v29, v74, v75
    v_max_f32 v76, 0, v76
    v_max_f32 v77, 0, v77
    s_waitcnt lgkmcnt(11)
    v_mfma_f32_32x32x16_bf16 v[96:111], v[40:43], v[148:151], v[96:111]
    ds_read_b64_tr_b16 v[32:33], v5 offset:8192
    ds_read_b64_tr_b16 v[34:35], v5 offset:8704
    v_mul_f32 v76, v76, v92
    v_mul_f32 v77, v77, v93
    v_cvt_pk_bf16_f32 v30, v76, v77
    v_max_f32 v78, 0, v78
    s_waitcnt lgkmcnt(11)
    v_mfma_f32_32x32x16_bf16 v[112:127], v[44:47], v[148:151], v[112:127]
    ds_read_b64_tr_b16 v[36:37], v5 offset:40960
    ds_read_b64_tr_b16 v[38:39], v5 offset:41472
    v_max_f32 v79, 0, v79
    v_mul_f32 v78, v78, v94
    v_mul_f32 v79, v79, v95
    v_cvt_pk_bf16_f32 v31, v78, v79
    s_waitcnt lgkmcnt(11)
    v_mfma_f32_32x32x16_bf16 v[96:111], v[48:51], v[152:155], v[96:111]
    ds_read_b64_tr_b16 v[40:41], v5 offset:9216
    ds_read_b64_tr_b16 v[42:43], v5 offset:9728
    s_cmp_lg_u32 s76, 0
    s_cbranch_scc1 Lsafe_82
    buffer_store_dwordx4 v[24:27], v2, s[44:47], s10 offen
    buffer_store_dwordx4 v[28:31], v2, s[44:47], s10 offen offset:1024
Lback_83:
    s_add_u32 s10, s10, 0xffe00000
    s_waitcnt lgkmcnt(11)
    v_mfma_f32_32x32x16_bf16 v[112:127], v[52:55], v[152:155], v[112:127]
    ds_read_b64_tr_b16 v[44:45], v5 offset:41984
    ds_read_b64_tr_b16 v[46:47], v5 offset:42496
    s_waitcnt lgkmcnt(11)
    v_mfma_f32_32x32x16_bf16 v[96:111], v[56:59], v[156:159], v[96:111]
    ds_read_b64_tr_b16 v[48:49], v5 offset:10240
    ds_read_b64_tr_b16 v[50:51], v5 offset:10752
    s_waitcnt lgkmcnt(11)
    v_mfma_f32_32x32x16_bf16 v[112:127], v[60:63], v[156:159], v[112:127]
    ds_read_b64_tr_b16 v[52:53], v5 offset:43008
    ds_read_b64_tr_b16 v[54:55], v5 offset:43520
    s_waitcnt lgkmcnt(10)
    v_mfma_f32_32x32x16_bf16 v[96:111], v[32:35], v[160:163], v[96:111]
    ds_read_b64_tr_b16 v[56:57], v5 offset:11264
    ds_read_b64_tr_b16 v[58:59], v5 offset:11776
    s_waitcnt lgkmcnt(10)
    v_mfma_f32_32x32x16_bf16 v[112:127], v[36:39], v[160:163], v[112:127]
    ds_read_b64_tr_b16 v[60:61], v5 offset:44032
    ds_read_b64_tr_b16 v[62:63], v5 offset:44544
    s_waitcnt lgkmcnt(10)
    v_mfma_f32_32x32x16_bf16 v[96:111], v[40:43], v[164:167], v[96:111]
    ds_read_b64_tr_b16 v[32:33], v5 offset:12288
    ds_read_b64_tr_b16 v[34:35], v5 offset:12800
    s_waitcnt lgkmcnt(10)
    v_mfma_f32_32x32x16_bf16 v[112:127], v[44:47], v[164:167], v[112:127]
    ds_read_b64_tr_b16 v[36:37], v5 offset:45056
    ds_read_b64_tr_b16 v[38:39], v5 offset:45568
    s_waitcnt lgkmcnt(10)
    v_mfma_f32_32x32x16_bf16 v[96:111], v[48:51], v[168:171], v[96:111]
    ds_read_b64_tr_b16 v[40:41], v5 offset:13312
    ds_read_b64_tr_b16 v[42:43], v5 offset:13824
    s_waitcnt lgkmcnt(10)
    v_mfma_f32_32x32x16_bf16 v[112:127], v[52:55], v[168:171], v[112:127]
    ds_read_b64_tr_b16 v[44:45], v5 offset:46080
    ds_read_b64_tr_b16 v[46:47], v5 offset:46592
    s_waitcnt lgkmcnt(10)
    v_mfma_f32_32x32x16_bf16 v[96:111], v[56:59], v[172:175], v[96:111]
    ds_read_b64_tr_b16 v[48:49], v5 offset:14336
    ds_read_b64_tr_b16 v[50:51], v5 offset:14848
    s_waitcnt lgkmcnt(10)
    v_mfma_f32_32x32x16_bf16 v[112:127], v[60:63], v[172:175], v[112:127]
    ds_read_b64_tr_b16 v[52:53], v5 offset:47104
    ds_read_b64_tr_b16 v[54:55], v5 offset:47616
    s_waitcnt lgkmcnt(10)
    v_mfma_f32_32x32x16_bf16 v[96:111], v[32:35], v[176:179], v[96:111]
    ds_read_b64_tr_b16 v[56:57], v5 offset:15360
    ds_read_b64_tr_b16 v[58:59], v5 offset:15872
    s_waitcnt lgkmcnt(10)
    v_mfma_f32_32x32x16_bf16 v[112:127], v[36:39], v[176:179], v[112:127]
    ds_read_b64_tr_b16 v[60:61], v5 offset:48128
    ds_read_b64_tr_b16 v[62:63], v5 offset:48640
    ds_write_b8 v7, v9 offset:336
    s_waitcnt lgkmcnt(11)
    v_mfma_f32_32x32x16_bf16 v[96:111], v[40:43], v[180:183], v[96:111]
    ds_read_b64_tr_b16 v[32:33], v5 offset:16384
    ds_read_b64_tr_b16 v[34:35], v5 offset:16896
    s_waitcnt lgkmcnt(11)
    v_mfma_f32_32x32x16_bf16 v[112:127], v[44:47], v[180:183], v[112:127]
    ds_read_b64_tr_b16 v[36:37], v5 offset:49152
    ds_read_b64_tr_b16 v[38:39], v5 offset:49664
    s_waitcnt vmcnt(0)
    s_cmp_lg_u32 s76, 0
    s_cbranch_scc1 Lsafe_84
    buffer_store_dword v12, v13, s[44:47], s11 offen
Lback_85:
    s_add_u32 s11, s11, 0x2000
    s_waitcnt lgkmcnt(11)
    v_mfma_f32_32x32x16_bf16 v[96:111], v[48:51], v[184:187], v[96:111]
    ds_read_b64_tr_b16 v[40:41], v5 offset:17408
    ds_read_b64_tr_b16 v[42:43], v5 offset:17920
    s_waitcnt lgkmcnt(11)
    v_mfma_f32_32x32x16_bf16 v[112:127], v[52:55], v[184:187], v[112:127]
    ds_read_b64_tr_b16 v[44:45], v5 offset:50176
    ds_read_b64_tr_b16 v[46:47], v5 offset:50688
    s_waitcnt lgkmcnt(11)
    v_mfma_f32_32x32x16_bf16 v[96:111], v[56:59], v[188:191], v[96:111]
    ds_read_b64_tr_b16 v[48:49], v5 offset:18432
    ds_read_b64_tr_b16 v[50:51], v5 offset:18944
    s_waitcnt lgkmcnt(11)
    v_mfma_f32_32x32x16_bf16 v[112:127], v[60:63], v[188:191], v[112:127]
    ds_read_b64_tr_b16 v[52:53], v5 offset:51200
    ds_read_b64_tr_b16 v[54:55], v5 offset:51712
    s_waitcnt lgkmcnt(10)
    v_mfma_f32_32x32x16_bf16 v[96:111], v[32:35], v[192:195], v[96:111]
    ds_read_b64_tr_b16 v[56:57], v5 offset:19456
    ds_read_b64_tr_b16 v[58:59], v5 offset:19968
    s_waitcnt lgkmcnt(10)
    v_mfma_f32_32x32x16_bf16 v[112:127], v[36:39], v[192:195], v[112:127]
    ds_read_b64_tr_b16 v[60:61], v5 offset:52224
    ds_read_b64_tr_b16 v[62:63], v5 offset:52736
    s_waitcnt lgkmcnt(10)
    v_mfma_f32_32x32x16_bf16 v[96:111], v[40:43], v[196:199], v[96:111]
    ds_read_b64_tr_b16 v[32:33], v5 offset:20480
    ds_read_b64_tr_b16 v[34:35], v5 offset:20992
    s_waitcnt lgkmcnt(10)
    v_mfma_f32_32x32x16_bf16 v[112:127], v[44:47], v[196:199], v[112:127]
    ds_read_b64_tr_b16 v[36:37], v5 offset:53248
    ds_read_b64_tr_b16 v[38:39], v5 offset:53760
    s_waitcnt lgkmcnt(10)
    v_mfma_f32_32x32x16_bf16 v[96:111], v[48:51], v[200:203], v[96:111]
    ds_read_b64_tr_b16 v[40:41], v5 offset:21504
    ds_read_b64_tr_b16 v[42:43], v5 offset:22016
    s_waitcnt lgkmcnt(10)
    v_mfma_f32_32x32x16_bf16 v[112:127], v[52:55], v[200:203], v[112:127]
    ds_read_b64_tr_b16 v[44:45], v5 offset:54272
    ds_read_b64_tr_b16 v[46:47], v5 offset:54784
    s_waitcnt lgkmcnt(10)
    v_mfma_f32_32x32x16_bf16 v[96:111], v[56:59], v[204:207], v[96:111]
    ds_read_b64_tr_b16 v[48:49], v5 offset:22528
    ds_read_b64_tr_b16 v[50:51], v5 offset:23040
    s_waitcnt lgkmcnt(10)
    v_mfma_f32_32x32x16_bf16 v[112:127], v[60:63], v[204:207], v[112:127]
    ds_read_b64_tr_b16 v[52:53], v5 offset:55296
    ds_read_b64_tr_b16 v[54:55], v5 offset:55808
    s_waitcnt lgkmcnt(10)
    v_mfma_f32_32x32x16_bf16 v[96:111], v[32:35], v[208:211], v[96:111]
    ds_read_b64_tr_b16 v[56:57], v5 offset:23552
    ds_read_b64_tr_b16 v[58:59], v5 offset:24064
    s_waitcnt lgkmcnt(10)
    v_mfma_f32_32x32x16_bf16 v[112:127], v[36:39], v[208:211], v[112:127]
    ds_read_b64_tr_b16 v[60:61], v5 offset:56320
    ds_read_b64_tr_b16 v[62:63], v5 offset:56832
    ds_write_b8 v7, v9 offset:352
    s_waitcnt lgkmcnt(11)
    v_mfma_f32_32x32x16_bf16 v[96:111], v[40:43], v[212:215], v[96:111]
    ds_read_b64_tr_b16 v[32:33], v5 offset:24576
    ds_read_b64_tr_b16 v[34:35], v5 offset:25088
    s_waitcnt lgkmcnt(11)
    v_mfma_f32_32x32x16_bf16 v[112:127], v[44:47], v[212:215], v[112:127]
    ds_read_b64_tr_b16 v[36:37], v5 offset:57344
    ds_read_b64_tr_b16 v[38:39], v5 offset:57856
    s_waitcnt lgkmcnt(11)
    v_mfma_f32_32x32x16_bf16 v[96:111], v[48:51], v[216:219], v[96:111]
    ds_read_b64_tr_b16 v[40:41], v5 offset:25600
    ds_read_b64_tr_b16 v[42:43], v5 offset:26112
    s_waitcnt lgkmcnt(11)
    v_mfma_f32_32x32x16_bf16 v[112:127], v[52:55], v[216:219], v[112:127]
    ds_read_b64_tr_b16 v[44:45], v5 offset:58368
    ds_read_b64_tr_b16 v[46:47], v5 offset:58880
    s_waitcnt lgkmcnt(11)
    v_mfma_f32_32x32x16_bf16 v[96:111], v[56:59], v[220:223], v[96:111]
    ds_read_b64_tr_b16 v[48:49], v5 offset:26624
    ds_read_b64_tr_b16 v[50:51], v5 offset:27136
    s_waitcnt lgkmcnt(11)
    v_mfma_f32_32x32x16_bf16 v[112:127], v[60:63], v[220:223], v[112:127]
    ds_read_b64_tr_b16 v[52:53], v5 offset:59392
    ds_read_b64_tr_b16 v[54:55], v5 offset:59904
    s_waitcnt lgkmcnt(10)
    v_mfma_f32_32x32x16_bf16 v[96:111], v[32:35], v[224:227], v[96:111]
    ds_read_b64_tr_b16 v[56:57], v5 offset:27648
    ds_read_b64_tr_b16 v[58:59], v5 offset:28160
    s_waitcnt lgkmcnt(10)
    v_mfma_f32_32x32x16_bf16 v[112:127], v[36:39], v[224:227], v[112:127]
    ds_read_b64_tr_b16 v[60:61], v5 offset:60416
    ds_read_b64_tr_b16 v[62:63], v5 offset:60928
    s_waitcnt lgkmcnt(10)
    v_mfma_f32_32x32x16_bf16 v[96:111], v[40:43], v[228:231], v[96:111]
    ds_read_b64_tr_b16 v[32:33], v5 offset:28672
    ds_read_b64_tr_b16 v[34:35], v5 offset:29184
    s_waitcnt lgkmcnt(10)
    v_mfma_f32_32x32x16_bf16 v[112:127], v[44:47], v[228:231], v[112:127]
    ds_read_b64_tr_b16 v[36:37], v5 offset:61440
    ds_read_b64_tr_b16 v[38:39], v5 offset:61952
    s_waitcnt lgkmcnt(10)
    v_mfma_f32_32x32x16_bf16 v[96:111], v[48:51], v[232:235], v[96:111]
    ds_read_b64_tr_b16 v[40:41], v5 offset:29696
    ds_read_b64_tr_b16 v[42:43], v5 offset:30208
    s_waitcnt lgkmcnt(10)
    v_mfma_f32_32x32x16_bf16 v[112:127], v[52:55], v[232:235], v[112:127]
    ds_read_b64_tr_b16 v[44:45], v5 offset:62464
    ds_read_b64_tr_b16 v[46:47], v5 offset:62976
    ds_read_b32 v20, v8 offset:128
    s_waitcnt lgkmcnt(11)
    v_mfma_f32_32x32x16_bf16 v[96:111], v[56:59], v[236:239], v[96:111]
    ds_read_b64_tr_b16 v[48:49], v5 offset:30720
    ds_read_b64_tr_b16 v[50:51], v5 offset:31232
    s_waitcnt lgkmcnt(11)
    v_mfma_f32_32x32x16_bf16 v[112:127], v[60:63], v[236:239], v[112:127]
    ds_read_b64_tr_b16 v[52:53], v5 offset:63488
    ds_read_b64_tr_b16 v[54:55], v5 offset:64000
    s_waitcnt lgkmcnt(11)
    v_mfma_f32_32x32x16_bf16 v[96:111], v[32:35], v[240:243], v[96:111]
    ds_read_b64_tr_b16 v[56:57], v5 offset:31744
    ds_read_b64_tr_b16 v[58:59], v5 offset:32256
    s_waitcnt lgkmcnt(11)
    v_mfma_f32_32x32x16_bf16 v[112:127], v[36:39], v[240:243], v[112:127]
    ds_read_b64_tr_b16 v[60:61], v5 offset:64512
    ds_read_b64_tr_b16 v[62:63], v5 offset:65024
    ds_write_b8 v7, v9 offset:368
    s_waitcnt lgkmcnt(12)
    v_mfma_f32_32x32x16_bf16 v[96:111], v[40:43], v[244:247], v[96:111]
    s_waitcnt lgkmcnt(9)
    v_cmp_ne_u32 vcc, 0x01010101, v20
    s_cbranch_vccnz Lspin_86
Lspinb_87:
    ds_read_b64_tr_b16 v[32:33], v3 offset:0
    ds_read_b64_tr_b16 v[34:35], v3 offset:512
    v_mfma_f32_32x32x16_bf16 v[112:127], v[44:47], v[244:247], v[112:127]
    ds_read_b64_tr_b16 v[36:37], v3 offset:32768
    ds_read_b64_tr_b16 v[38:39], v3 offset:33280
    s_waitcnt lgkmcnt(11)
    v_mfma_f32_32x32x16_bf16 v[96:111], v[48:51], v[248:251], v[96:111]
    ds_read_b64_tr_b16 v[40:41], v3 offset:1024
    ds_read_b64_tr_b16 v[42:43], v3 offset:1536
    s_waitcnt lgkmcnt(11)
    v_mfma_f32_32x32x16_bf16 v[112:127], v[52:55], v[248:251], v[112:127]
    ds_read_b64_tr_b16 v[44:45], v3 offset:33792
    ds_read_b64_tr_b16 v[46:47], v3 offset:34304
    s_waitcnt lgkmcnt(11)
    v_mfma_f32_32x32x16_bf16 v[96:111], v[56:59], v[252:255], v[96:111]
    ds_read_b64_tr_b16 v[48:49], v3 offset:2048
    ds_read_b64_tr_b16 v[50:51], v3 offset:2560
    s_waitcnt lgkmcnt(11)
    v_mfma_f32_32x32x16_bf16 v[112:127], v[60:63], v[252:255], v[112:127]
    ds_read_b64_tr_b16 v[52:53], v3 offset:34816
    ds_read_b64_tr_b16 v[54:55], v3 offset:35328
    s_cmp_ge_u32 s15, 11
    s_cbranch_scc1 Ltwo_77
    s_waitcnt lgkmcnt(10)
    v_mfma_f32_32x32x16_bf16 v[64:79], v[32:35], v[128:131], 0
    ds_read_b64_tr_b16 v[56:57], v3 offset:3072
    ds_read_b64_tr_b16 v[58:59], v3 offset:3584
    buffer_load_dword v6, v4, s[44:47], s9 offen sc1
    s_waitcnt lgkmcnt(10)
    v_mfma_f32_32x32x16_bf16 v[80:95], v[36:39], v[128:131], 0
    ds_read_b64_tr_b16 v[60:61], v3 offset:35840
    ds_read_b64_tr_b16 v[62:63], v3 offset:36352
    s_waitcnt lgkmcnt(10)
    v_mfma_f32_32x32x16_bf16 v[64:79], v[40:43], v[132:135], v[64:79]
    ds_read_b64_tr_b16 v[32:33], v3 offset:4096
    ds_read_b64_tr_b16 v[34:35], v3 offset:4608
    v_max_f32 v96, 0, v96
    v_max_f32 v97, 0, v97
    v_mul_f32 v96, v96, v112
    v_mul_f32 v97, v97, v113
    s_waitcnt lgkmcnt(10)
    v_mfma_f32_32x32x16_bf16 v[80:95], v[44:47], v[132:135], v[80:95]
    ds_read_b64_tr_b16 v[36:37], v3 offset:36864
    ds_read_b64_tr_b16 v[38:39], v3 offset:37376
    v_cvt_pk_bf16_f32 v24, v96, v97
    v_max_f32 v98, 0, v98
    v_max_f32 v99, 0, v99
    v_mul_f32 v98, v98, v114
    s_waitcnt lgkmcnt(10)
    v_mfma_f32_32x32x16_bf16 v[64:79], v[48:51], v[136:139], v[64:79]
    ds_read_b64_tr_b16 v[40:41], v3 offset:5120
    ds_read_b64_tr_b16 v[42:43], v3 offset:5632
    v_mul_f32 v99, v99, v115
    v_cvt_pk_bf16_f32 v25, v98, v99
    v_max_f32 v100, 0, v100
    v_max_f32 v101, 0, v101
    s_waitcnt lgkmcnt(10)
    v_mfma_f32_32x32x16_bf16 v[80:95], v[52:55], v[136:139], v[80:95]
    ds_read_b64_tr_b16 v[44:45], v3 offset:37888
    ds_read_b64_tr_b16 v[46:47], v3 offset:38400
    v_mul_f32 v100, v100, v116
    v_mul_f32 v101, v101, v117
    v_cvt_pk_bf16_f32 v26, v100, v101
    v_max_f32 v102, 0, v102
    s_waitcnt lgkmcnt(10)
    v_mfma_f32_32x32x16_bf16 v[64:79], v[56:59], v[140:143], v[64:79]
    ds_read_b64_tr_b16 v[48:49], v3 offset:6144
    ds_read_b64_tr_b16 v[50:51], v3 offset:6656
    v_max_f32 v103, 0, v103
    v_mul_f32 v102, v102, v118
    v_mul_f32 v103, v103, v119
    v_cvt_pk_bf16_f32 v27, v102, v103
    s_waitcnt lgkmcnt(10)
    v_mfma_f32_32x32x16_bf16 v[80:95], v[60:63], v[140:143], v[80:95]
    ds_read_b64_tr_b16 v[52:53], v3 offset:38912
    ds_read_b64_tr_b16 v[54:55], v3 offset:39424
    v_max_f32 v104, 0, v104
    v_max_f32 v105, 0, v105
    v_mul_f32 v104, v104, v120
    v_mul_f32 v105, v105, v121
    s_waitcnt lgkmcnt(10)
    v_mfma_f32_32x32x16_bf16 v[64:79], v[32:35], v[144:147], v[64:79]
    ds_read_b64_tr_b16 v[56:57], v3 offset:7168
    ds_read_b64_tr_b16 v[58:59], v3 offset:7680
    v_cvt_pk_bf16_f32 v28, v104, v105
    v_max_f32 v106, 0, v106
    v_max_f32 v107, 0, v107
    v_mul_f32 v106, v106, v122
    s_waitcnt lgkmcnt(10)
    v_mfma_f32_32x32x16_bf16 v[80:95], v[36:39], v[144:147], v[80:95]
    ds_read_b64_tr_b16 v[60:61], v3 offset:39936
    ds_read_b64_tr_b16 v[62:63], v3 offset:40448
    ds_write_b8 v7, v9 offset:384
    v_mul_f32 v107, v107, v123
    v_cvt_pk_bf16_f32 v29, v106, v107
    v_max_f32 v108, 0, v108
    v_max_f32 v109, 0, v109
    s_waitcnt lgkmcnt(11)
    v_mfma_f32_32x32x16_bf16 v[64:79], v[40:43], v[148:151], v[64:79]
    ds_read_b64_tr_b16 v[32:33], v3 offset:8192
    ds_read_b64_tr_b16 v[34:35], v3 offset:8704
    v_mul_f32 v108, v108, v124
    v_mul_f32 v109, v109, v125
    v_cvt_pk_bf16_f32 v30, v108, v109
    v_max_f32 v110, 0, v110
    s_waitcnt lgkmcnt(11)
    v_mfma_f32_32x32x16_bf16 v[80:95], v[44:47], v[148:151], v[80:95]
    ds_read_b64_tr_b16 v[36:37], v3 offset:40960
    ds_read_b64_tr_b16 v[38:39], v3 offset:41472
    v_max_f32 v111, 0, v111
    v_mul_f32 v110, v110, v126
    v_mul_f32 v111, v111, v127
    v_cvt_pk_bf16_f32 v31, v110, v111
    s_waitcnt lgkmcnt(11)
    v_mfma_f32_32x32x16_bf16 v[64:79], v[48:51], v[152:155], v[64:79]
    ds_read_b64_tr_b16 v[40:41], v3 offset:9216
    ds_read_b64_tr_b16 v[42:43], v3 offset:9728
    s_waitcnt vmcnt(0)
    v_cmp_ne_u32 vcc, s75, v6
    s_cbranch_vccnz Lchk_88
Lchkb_89:
    s_cmp_lg_u32 s76, 0
    s_cbranch_scc1 Lsafe_90
    buffer_store_dwordx4 v[24:27], v2, s[44:47], s10 offen
    buffer_store_dwordx4 v[28:31], v2, s[44:47], s10 offen offset:1024
Lback_91:
    s_add_u32 s10, s10, 0x400000
    s_waitcnt lgkmcnt(11)
    v_mfma_f32_32x32x16_bf16 v[80:95], v[52:55], v[152:155], v[80:95]
    ds_read_b64_tr_b16 v[44:45], v3 offset:41984
    ds_read_b64_tr_b16 v[46:47], v3 offset:42496
    s_waitcnt lgkmcnt(11)
    v_mfma_f32_32x32x16_bf16 v[64:79], v[56:59], v[156:159], v[64:79]
    ds_read_b64_tr_b16 v[48:49], v3 offset:10240
    ds_read_b64_tr_b16 v[50:51], v3 offset:10752
    s_waitcnt lgkmcnt(11)
    v_mfma_f32_32x32x16_bf16 v[80:95], v[60:63], v[156:159], v[80:95]
    ds_read_b64_tr_b16 v[52:53], v3 offset:43008
    ds_read_b64_tr_b16 v[54:55], v3 offset:43520
    s_waitcnt lgkmcnt(10)
    v_mfma_f32_32x32x16_bf16 v[64:79], v[32:35], v[160:163], v[64:79]
    ds_read_b64_tr_b16 v[56:57], v3 offset:11264
    ds_read_b64_tr_b16 v[58:59], v3 offset:11776
    s_waitcnt lgkmcnt(10)
    v_mfma_f32_32x32x16_bf16 v[80:95], v[36:39], v[160:163], v[80:95]
    ds_read_b64_tr_b16 v[60:61], v3 offset:44032
    ds_read_b64_tr_b16 v[62:63], v3 offset:44544
    s_waitcnt lgkmcnt(10)
    v_mfma_f32_32x32x16_bf16 v[64:79], v[40:43], v[164:167], v[64:79]
    ds_read_b64_tr_b16 v[32:33], v3 offset:12288
    ds_read_b64_tr_b16 v[34:35], v3 offset:12800
    s_waitcnt lgkmcnt(10)
    v_mfma_f32_32x32x16_bf16 v[80:95], v[44:47], v[164:167], v[80:95]
    ds_read_b64_tr_b16 v[36:37], v3 offset:45056
    ds_read_b64_tr_b16 v[38:39], v3 offset:45568
    s_waitcnt lgkmcnt(10)
    v_mfma_f32_32x32x16_bf16 v[64:79], v[48:51], v[168:171], v[64:79]
    ds_read_b64_tr_b16 v[40:41], v3 offset:13312
    ds_read_b64_tr_b16 v[42:43], v3 offset:13824
    s_waitcnt lgkmcnt(10)
    v_mfma_f32_32x32x16_bf16 v[80:95], v[52:55], v[168:171], v[80:95]
    ds_read_b64_tr_b16 v[44:45], v3 offset:46080
    ds_read_b64_tr_b16 v[46:47], v3 offset:46592
    s_waitcnt lgkmcnt(10)
    v_mfma_f32_32x32x16_bf16 v[64:79], v[56:59], v[172:175], v[64:79]
    ds_read_b64_tr_b16 v[48:49], v3 offset:14336
    ds_read_b64_tr_b16 v[50:51], v3 offset:14848
    s_waitcnt lgkmcnt(10)
    v_mfma_f32_32x32x16_bf16 v[80:95], v[60:63], v[172:175], v[80:95]
    ds_read_b64_tr_b16 v[52:53], v3 offset:47104
    ds_read_b64_tr_b16 v[54:55], v3 offset:47616
    s_waitcnt lgkmcnt(10)
    v_mfma_f32_32x32x16_bf16 v[64:79], v[32:35], v[176:179], v[64:79]
    ds_read_b64_tr_b16 v[56:57], v3 offset:15360
    ds_read_b64_tr_b16 v[58:59], v3 offset:15872
    s_waitcnt lgkmcnt(10)
    v_mfma_f32_32x32x16_bf16 v[80:95], v[36:39], v[176:179], v[80:95]
    ds_read_b64_tr_b16 v[60:61], v3 offset:48128
    ds_read_b64_tr_b16 v[62:63], v3 offset:48640
    ds_write_b8 v7, v9 offset:400
    s_waitcnt lgkmcnt(11)
    v_mfma_f32_32x32x16_bf16 v[64:79], v[40:43], v[180:183], v[64:79]
    ds_read_b64_tr_b16 v[32:33], v3 offset:16384
    ds_read_b64_tr_b16 v[34:35], v3 offset:16896
    s_waitcnt lgkmcnt(11)
    v_mfma_f32_32x32x16_bf16 v[80:95], v[44:47], v[180:183], v[80:95]
    ds_read_b64_tr_b16 v[36:37], v3 offset:49152
    ds_read_b64_tr_b16 v[38:39], v3 offset:49664
    s_waitcnt vmcnt(0)
    s_cmp_lg_u32 s76, 0
    s_cbranch_scc1 Lsafe_92
    buffer_store_dword v12, v13, s[44:47], s11 offen
Lback_93:
    s_add_u32 s11, s11, 0x2000
    s_waitcnt lgkmcnt(11)
    v_mfma_f32_32x32x16_bf16 v[64:79], v[48:51], v[184:187], v[64:79]
    ds_read_b64_tr_b16 v[40:41], v3 offset:17408
    ds_read_b64_tr_b16 v[42:43], v3 offset:17920
    s_waitcnt lgkmcnt(11)
    v_mfma_f32_32x32x16_bf16 v[80:95], v[52:55], v[184:187], v[80:95]
    ds_read_b64_tr_b16 v[44:45], v3 offset:50176
    ds_read_b64_tr_b16 v[46:47], v3 offset:50688
    s_waitcnt lgkmcnt(11)
    v_mfma_f32_32x32x16_bf16 v[64:79], v[56:59], v[188:191], v[64:79]
    ds_read_b64_tr_b16 v[48:49], v3 offset:18432
    ds_read_b64_tr_b16 v[50:51], v3 offset:18944
    s_waitcnt lgkmcnt(11)
    v_mfma_f32_32x32x16_bf16 v[80:95], v[60:63], v[188:191], v[80:95]
    ds_read_b64_tr_b16 v[52:53], v3 offset:51200
    ds_read_b64_tr_b16 v[54:55], v3 offset:51712
    s_waitcnt lgkmcnt(10)
    v_mfma_f32_32x32x16_bf16 v[64:79], v[32:35], v[192:195], v[64:79]
    ds_read_b64_tr_b16 v[56:57], v3 offset:19456
    ds_read_b64_tr_b16 v[58:59], v3 offset:19968
    s_waitcnt lgkmcnt(10)
    v_mfma_f32_32x32x16_bf16 v[80:95], v[36:39], v[192:195], v[80:95]
    ds_read_b64_tr_b16 v[60:61], v3 offset:52224
    ds_read_b64_tr_b16 v[62:63], v3 offset:52736
    s_waitcnt lgkmcnt(10)
    v_mfma_f32_32x32x16_bf16 v[64:79], v[40:43], v[196:199], v[64:79]
    ds_read_b64_tr_b16 v[32:33], v3 offset:20480
    ds_read_b64_tr_b16 v[34:35], v3 offset:20992
    s_waitcnt lgkmcnt(10)
    v_mfma_f32_32x32x16_bf16 v[80:95], v[44:47], v[196:199], v[80:95]
    ds_read_b64_tr_b16 v[36:37], v3 offset:53248
    ds_read_b64_tr_b16 v[38:39], v3 offset:53760
    s_waitcnt lgkmcnt(10)
    v_mfma_f32_32x32x16_bf16 v[64:79], v[48:51], v[200:203], v[64:79]
    ds_read_b64_tr_b16 v[40:41], v3 offset:21504
    ds_read_b64_tr_b16 v[42:43], v3 offset:22016
    s_waitcnt lgkmcnt(10)
    v_mfma_f32_32x32x16_bf16 v[80:95], v[52:55], v[200:203], v[80:95]
    ds_read_b64_tr_b16 v[44:45], v3 offset:54272
    ds_read_b64_tr_b16 v[46:47], v3 offset:54784
    s_waitcnt lgkmcnt(10)
    v_mfma_f32_32x32x16_bf16 v[64:79], v[56:59], v[204:207], v[64:79]
    ds_read_b64_tr_b16 v[48:49], v3 offset:22528
    ds_read_b64_tr_b16 v[50:51], v3 offset:23040
    s_waitcnt lgkmcnt(10)
    v_mfma_f32_32x32x16_bf16 v[80:95], v[60:63], v[204:207], v[80:95]
    ds_read_b64_tr_b16 v[52:53], v3 offset:55296
    ds_read_b64_tr_b16 v[54:55], v3 offset:55808
    s_waitcnt lgkmcnt(10)
    v_mfma_f32_32x32x16_bf16 v[64:79], v[32:35], v[208:211], v[64:79]
    ds_read_b64_tr_b16 v[56:57], v3 offset:23552
    ds_read_b64_tr_b16 v[58:59], v3 offset:24064
    s_waitcnt lgkmcnt(10)
    v_mfma_f32_32x32x16_bf16 v[80:95], v[36:39], v[208:211], v[80:95]
    ds_read_b64_tr_b16 v[60:61], v3 offset:56320
    ds_read_b64_tr_b16 v[62:63], v3 offset:56832
    ds_write_b8 v7, v9 offset:416
    s_waitcnt lgkmcnt(11)
    v_mfma_f32_32x32x16_bf16 v[64:79], v[40:43], v[212:215], v[64:79]
    ds_read_b64_tr_b16 v[32:33], v3 offset:24576
    ds_read_b64_tr_b16 v[34:35], v3 offset:25088
    s_waitcnt lgkmcnt(11)
    v_mfma_f32_32x32x16_bf16 v[80:95], v[44:47], v[212:215], v[80:95]
    ds_read_b64_tr_b16 v[36:37], v3 offset:57344
    ds_read_b64_tr_b16 v[38:39], v3 offset:57856
    s_waitcnt lgkmcnt(11)
    v_mfma_f32_32x32x16_bf16 v[64:79], v[48:51], v[216:219], v[64:79]
    ds_read_b64_tr_b16 v[40:41], v3 offset:25600
    ds_read_b64_tr_b16 v[42:43], v3 offset:26112
    s_waitcnt lgkmcnt(11)
    v_mfma_f32_32x32x16_bf16 v[80:95], v[52:55], v[216:219], v[80:95]
    ds_read_b64_tr_b16 v[44:45], v3 offset:58368
    ds_read_b64_tr_b16 v[46:47], v3 offset:58880
    s_waitcnt lgkmcnt(11)
    v_mfma_f32_32x32x16_bf16 v[64:79], v[56:59], v[220:223], v[64:79]
    ds_read_b64_tr_b16 v[48:49], v3 offset:26624
    ds_read_b64_tr_b16 v[50:51], v3 offset:27136
    s_waitcnt lgkmcnt(11)
    v_mfma_f32_32x32x16_bf16 v[80:95], v[60:63], v[220:223], v[80:95]
    ds_read_b64_tr_b16 v[52:53], v3 offset:59392
    ds_read_b64_tr_b16 v[54:55], v3 offset:59904
    s_waitcnt lgkmcnt(10)
    v_mfma_f32_32x32x16_bf16 v[64:79], v[32:35], v[224:227], v[64:79]
    ds_read_b64_tr_b16 v[56:57], v3 offset:27648
    ds_read_b64_tr_b16 v[58:59], v3 offset:28160
    s_waitcnt lgkmcnt(10)
    v_mfma_f32_32x32x16_bf16 v[80:95], v[36:39], v[224:227], v[80:95]
    ds_read_b64_tr_b16 v[60:61], v3 offset:60416
    ds_read_b64_tr_b16 v[62:63], v3 offset:60928
    s_waitcnt lgkmcnt(10)
    v_mfma_f32_32x32x16_bf16 v[64:79], v[40:43], v[228:231], v[64:79]
    ds_read_b64_tr_b16 v[32:33], v3 offset:28672
    ds_read_b64_tr_b16 v[34:35], v3 offset:29184
    s_waitcnt lgkmcnt(10)
    v_mfma_f32_32x32x16_bf16 v[80:95], v[44:47], v[228:231], v[80:95]
    ds_read_b64_tr_b16 v[36:37], v3 offset:61440
    ds_read_b64_tr_b16 v[38:39], v3 offset:61952
    s_waitcnt lgkmcnt(10)
    v_mfma_f32_32x32x16_bf16 v[64:79], v[48:51], v[232:235], v[64:79]
    ds_read_b64_tr_b16 v[40:41], v3 offset:29696
    ds_read_b64_tr_b16 v[42:43], v3 offset:30208
    s_waitcnt lgkmcnt(10)
    v_mfma_f32_32x32x16_bf16 v[80:95], v[52:55], v[232:235], v[80:95]
    ds_read_b64_tr_b16 v[44:45], v3 offset:62464
    ds_read_b64_tr_b16 v[46:47], v3 offset:62976
    s_waitcnt lgkmcnt(10)
    v_mfma_f32_32x32x16_bf16 v[64:79], v[56:59], v[236:239], v[64:79]
    ds_read_b64_tr_b16 v[48:49], v3 offset:30720
    ds_read_b64_tr_b16 v[50:51], v3 offset:31232
    s_waitcnt lgkmcnt(10)
    v_mfma_f32_32x32x16_bf16 v[80:95], v[60:63], v[236:239], v[80:95]
    ds_read_b64_tr_b16 v[52:53], v3 offset:63488
    ds_read_b64_tr_b16 v[54:55], v3 offset:64000
    s_waitcnt lgkmcnt(10)
    v_mfma_f32_32x32x16_bf16 v[64:79], v[32:35], v[240:243], v[64:79]
    ds_read_b64_tr_b16 v[56:57], v3 offset:31744
    ds_read_b64_tr_b16 v[58:59], v3 offset:32256
    s_waitcnt lgkmcnt(10)
    v_mfma_f32_32x32x16_bf16 v[80:95], v[36:39], v[240:243], v[80:95]
    ds_read_b64_tr_b16 v[60:61], v3 offset:64512
    ds_read_b64_tr_b16 v[62:63], v3 offset:65024
    ds_write_b8 v7, v9 offset:432
    s_waitcnt lgkmcnt(11)
    v_mfma_f32_32x32x16_bf16 v[64:79], v[40:43], v[244:247], v[64:79]
    s_waitcnt lgkmcnt(9)
    v_mfma_f32_32x32x16_bf16 v[80:95], v[44:47], v[244:247], v[80:95]
    s_waitcnt lgkmcnt(7)
    v_mfma_f32_32x32x16_bf16 v[64:79], v[48:51], v[248:251], v[64:79]
    s_waitcnt lgkmcnt(5)
    v_mfma_f32_32x32x16_bf16 v[80:95], v[52:55], v[248:251], v[80:95]
    s_waitcnt lgkmcnt(3)
    v_mfma_f32_32x32x16_bf16 v[64:79], v[56:59], v[252:255], v[64:79]
    s_waitcnt lgkmcnt(1)
    v_mfma_f32_32x32x16_bf16 v[80:95], v[60:63], v[252:255], v[80:95]
    s_nop 9
    v_max_f32 v64, 0, v64
    v_max_f32 v65, 0, v65
    v_max_f32 v66, 0, v66
    v_max_f32 v67, 0, v67
    v_max_f32 v68, 0, v68
    v_max_f32 v69, 0, v69
    v_max_f32 v70, 0, v70
    v_max_f32 v71, 0, v71
    v_pk_mul_f32 v[64:65], v[64:65], v[80:81]
    v_pk_mul_f32 v[66:67], v[66:67], v[82:83]
    v_pk_mul_f32 v[68:69], v[68:69], v[84:85]
    v_pk_mul_f32 v[70:71], v[70:71], v[86:87]
    v_cvt_pk_bf16_f32 v24, v64, v65
    v_cvt_pk_bf16_f32 v25, v66, v67
    v_cvt_pk_bf16_f32 v26, v68, v69
    v_cvt_pk_bf16_f32 v27, v70, v71
    buffer_store_dwordx4 v[24:27], v2, s[44:47], s10 offen offset:0 sc1
    v_max_f32 v72, 0, v72
    v_max_f32 v73, 0, v73
    v_max_f32 v74, 0, v74
    v_max_f32 v75, 0, v75
    v_max_f32 v76, 0, v76
    v_max_f32 v77, 0, v77
    v_max_f32 v78, 0, v78
    v_max_f32 v79, 0, v79
    v_pk_mul_f32 v[72:73], v[72:73], v[88:89]
    v_pk_mul_f32 v[74:75], v[74:75], v[90:91]
    v_pk_mul_f32 v[76:77], v[76:77], v[92:93]
    v_pk_mul_f32 v[78:79], v[78:79], v[94:95]
    v_cvt_pk_bf16_f32 v28, v72, v73
    v_cvt_pk_bf16_f32 v29, v74, v75
    v_cvt_pk_bf16_f32 v30, v76, v77
    v_cvt_pk_bf16_f32 v31, v78, v79
    buffer_store_dwordx4 v[28:31], v2, s[44:47], s10 offen offset:1024 sc1
    s_branch Ltail_94
Ltwo_77:
    buffer_load_dword v6, v4, s[44:47], s9 offen sc1
    s_waitcnt vmcnt(0)
    v_cmp_ne_u32 vcc, s75, v6
    s_cbranch_vccnz Lchk_95
Lchkb_96:
    v_max_f32 v96, 0, v96
    v_max_f32 v97, 0, v97
    v_max_f32 v98, 0, v98
    v_max_f32 v99, 0, v99
    v_max_f32 v100, 0, v100
    v_max_f32 v101, 0, v101
    v_max_f32 v102, 0, v102
    v_max_f32 v103, 0, v103
    v_pk_mul_f32 v[96:97], v[96:97], v[112:113]
    v_pk_mul_f32 v[98:99], v[98:99], v[114:115]
    v_pk_mul_f32 v[100:101], v[100:101], v[116:117]
    v_pk_mul_f32 v[102:103], v[102:103], v[118:119]
    v_cvt_pk_bf16_f32 v24, v96, v97
    v_cvt_pk_bf16_f32 v25, v98, v99
    v_cvt_pk_bf16_f32 v26, v100, v101
    v_cvt_pk_bf16_f32 v27, v102, v103
    s_cmp_lg_u32 s76, 0
    s_cbranch_scc1 Lsafe_97
    buffer_store_dwordx4 v[24:27], v2, s[44:47], s10 offen offset:0
Lback_98:
    v_max_f32 v104, 0, v104
    v_max_f32 v105, 0, v105
    v_max_f32 v106, 0, v106
    v_max_f32 v107, 0, v107
    v_max_f32 v108, 0, v108
    v_max_f32 v109, 0, v109
    v_max_f32 v110, 0, v110
    v_max_f32 v111, 0, v111
    v_pk_mul_f32 v[104:105], v[104:105], v[120:121]
    v_pk_mul_f32 v[106:107], v[106:107], v[122:123]
    v_pk_mul_f32 v[108:109], v[108:109], v[124:125]
    v_pk_mul_f32 v[110:111], v[110:111], v[126:127]
    v_cvt_pk_bf16_f32 v28, v104, v105
    v_cvt_pk_bf16_f32 v29, v106, v107
    v_cvt_pk_bf16_f32 v30, v108, v109
    v_cvt_pk_bf16_f32 v31, v110, v111
    s_cmp_lg_u32 s76, 0
    s_cbranch_scc1 Lsafe_99
    buffer_store_dwordx4 v[28:31], v2, s[44:47], s10 offen offset:1024
Lback_100:
Ltail_94:
    s_waitcnt vmcnt(0)
    s_cmp_lg_u32 s76, 0
    s_cbranch_scc1 Lsafe_101
    buffer_store_dword v12, v13, s[44:47], s11 offen
Lback_102:
    s_add_u32 s11, s11, 0x2000
    s_setprio 0
    s_mov_b32 s56, s30
    s_mov_b32 s57, s31
    s_mov_b32 s58, 0x158000
    s_mov_b32 s59, 0x20000
    v_lshrrev_b32 v20, 2, v1
    v_mul_u32_u24 v20, 1024, v20
    v_and_b32 v10, 3, v1
    v_lshl_add_u32 v10, v10, 4, v20
    s_and_b32 s8, s73, 7
    s_lshl_b32 s8, s8, 7
Lev_104:
    ds_read_b32 v20, v8 offset:608
    s_waitcnt lgkmcnt(0)
    v_readfirstlane_b32 s98, v20
    s_nop 0
    s_cmp_eq_u32 s98, 0x01010101
    s_cbranch_scc1 Levd_105
    s_cmp_lg_u32 s98, 0
    s_cbranch_scc1 Levs_106
    s_sleep 3
Levs_106:
    s_sleep 1
    s_sub_u32 s77, s77, 1
    s_cbranch_scc1 L_end
    s_branch Lev_104
Levd_105:
    s_add_u32 s6, s74, 0
    s_mul_i32 s4, s6, 3
    s_add_u32 s4, s4, 18
    s_lshl_b32 s5, s4, 15
    s_add_u32 s5, s5, s8
    s_add_u32 s5, s5, 0x10000
    s_lshl_b32 s6, s6, 11
    s_add_u32 m0, s6, 0x10000
    s_nop 0
    buffer_load_dwordx4 v10, s[56:59], s5 offen lds
    s_add_u32 m0, s6, 0x103c0
    s_nop 0
    buffer_load_dwordx4 v10, s[56:59], s5 offen offset:64 lds
    s_add_u32 s5, s5, 0x4000
    s_add_u32 m0, s6, 0x18000
    s_nop 0
    buffer_load_dwordx4 v10, s[56:59], s5 offen lds
    s_add_u32 m0, s6, 0x183c0
    s_nop 0
    buffer_load_dwordx4 v10, s[56:59], s5 offen offset:64 lds
    s_cmp_ge_u32 s74, 1
    s_cbranch_scc1 Lw2_103
Lev_107:
    ds_read_b32 v20, v8 offset:624
    s_waitcnt lgkmcnt(0)
    v_readfirstlane_b32 s98, v20
    s_nop 0
    s_cmp_eq_u32 s98, 0x01010101
    s_cbranch_scc1 Levd_108
    s_cmp_lg_u32 s98, 0
    s_cbranch_scc1 Levs_109
    s_sleep 3
Levs_109:
    s_sleep 1
    s_sub_u32 s77, s77, 1
    s_cbranch_scc1 L_end
    s_branch Lev_107
Levd_108:
    s_add_u32 s6, s74, 4
    s_mul_i32 s4, s6, 3
    s_add_u32 s4, s4, 18
    s_lshl_b32 s5, s4, 15
    s_add_u32 s5, s5, s8
    s_add_u32 s5, s5, 0x10000
    s_lshl_b32 s6, s6, 11
    s_add_u32 m0, s6, 0x10000
    s_nop 0
    buffer_load_dwordx4 v10, s[56:59], s5 offen lds
    s_add_u32 m0, s6, 0x103c0
    s_nop 0
    buffer_load_dwordx4 v10, s[56:59], s5 offen offset:64 lds
    s_add_u32 s5, s5, 0x4000
    s_add_u32 m0, s6, 0x18000
    s_nop 0
    buffer_load_dwordx4 v10, s[56:59], s5 offen lds
    s_add_u32 m0, s6, 0x183c0
    s_nop 0
    buffer_load_dwordx4 v10, s[56:59], s5 offen offset:64 lds
Lw2_103:
Lev_110:
    ds_read_b32 v20, v8 offset:656
    s_waitcnt lgkmcnt(0)
    v_readfirstlane_b32 s98, v20
    s_nop 0
    s_cmp_eq_u32 s98, 0x01010101
    s_cbranch_scc1 Levd_111
    s_cmp_lg_u32 s98, 0
    s_cbranch_scc1 Levs_112
    s_sleep 3
Levs_112:
    s_sleep 1
    s_sub_u32 s77, s77, 1
    s_cbranch_scc1 L_end
    s_branch Lev_110
Levd_111:
    s_waitcnt vmcnt(0)
    ds_write_b8 v7, v9 offset:176
    s_endpgm
L_groupB:
    s_sub_u32 s74, s74, 4
    s_setprio 0
    v_and_b32 v19, 31, v1
    v_lshrrev_b32 v20, 5, v1
    v_lshlrev_b32 v10, 10, v19
    v_lshl_add_u32 v10, v20, 4, v10
    v_lshlrev_b32 v2, 4, v1
    v_and_b32 v18, 7, v1
    s_lshl_b32 s101, s12, 15
    s_lshl_b32 s4, s15, 12
    s_add_u32 s101, s101, s4
    s_lshl_b32 s4, s13, 11
    s_add_u32 s101, s101, s4
    s_add_u32 s3, s101, 0x200000
    s_lshl_b32 s5, s12, 7
    s_lshl_b32 s4, s15, 3
    s_add_u32 s5, s5, s4
    s_lshl_b32 s4, s13, 2
    s_add_u32 s5, s5, s4
    s_add_u32 s97, s5, 0x4000
    s_add_u32 s5, s5, 0xc000
    s_add_u32 s90, s40, s5
    s_addc_u32 s91, s41, 0
    s_and_b32 s90, s90, 0xffffff80
    s_load_dword s92, s[90:91], 0
    s_load_dword s93, s[90:91], 64
    s_lshl_b32 s6, s12, 9
    s_add_u32 s6, s6, 0x10000
    s_lshl_b32 s7, s72, 12
    s_lshl_b32 s8, s74, 10
    s_add_u32 s7, s7, s8
    s_add_u32 s7, s7, 0x10000
    s_lshl_b32 s10, s15, 13
    s_lshl_b32 s8, s74, 11
    s_add_u32 s10, s10, s8
    s_add_u32 s10, s10, 0x20000
    s_add_u32 s11, s10, 0x10000
    v_mov_b32 v6, 0x20000
    v_add_u32 v5, s74, v6
    s_xor_b32 s8, s74, 2
    v_add_u32 v13, s8, v6
    v_mov_b32 v7, 1
    v_mov_b32 v15, 0
    s_mov_b32 s77, 0x80000
    s_getreg_b32 s78, hwreg(HW_REG_XCC_ID)
    v_lshlrev_b32 v16, 4, v19
    v_lshlrev_b32 v17, 7, v18
    v_lshlrev_b32 v60, 5, v20
    s_lshl_b32 s8, s13, 7
    s_add_u32 s8, s8, 0x26900
    v_add_u32 v60, s8, v60
    v_bfe_u32 v59, v1, 4, 1
    v_lshl_add_u32 v58, v18, 1, v59
    v_lshlrev_b32 v58, 2, v58
    v_lshl_add_u32 v58, v20, 8, v58
    s_lshl_b32 s8, s74, 6
    s_add_u32 s8, s8, 0x26900
    v_add_u32 v58, s8, v58
    v_cvt_f32_u32 v59, v20
    s_waitcnt lgkmcnt(0)
    v_and_b32 v31, 15, v1
    v_lshlrev_b32 v31, 7, v31
    s_add_u32 s75, s75, 0x9e3779b9
    v_mov_b32 v14, s75
    s_waitcnt vmcnt(0)
    v_lshlrev_b32 v96, 16, v112
    v_and_b32 v97, 0xffff0000, v112
    v_lshlrev_b32 v98, 16, v113
    v_and_b32 v99, 0xffff0000, v113
    v_lshlrev_b32 v100, 16, v114
    v_and_b32 v101, 0xffff0000, v114
    v_lshlrev_b32 v102, 16, v115
    v_and_b32 v103, 0xffff0000, v115
    v_lshlrev_b32 v104, 16, v116
    v_and_b32 v105, 0xffff0000, v116
    v_lshlrev_b32 v106, 16, v117
    v_and_b32 v107, 0xffff0000, v117
    v_lshlrev_b32 v108, 16, v118
    v_and_b32 v109, 0xffff0000, v118
    v_lshlrev_b32 v110, 16, v119
    v_and_b32 v111, 0xffff0000, v119
    v_add_u32 v23, 1, v6
Lev_113:
    ds_read_u8 v22, v23 offset:592
    s_waitcnt lgkmcnt(0)
    v_cmp_eq_u32 vcc, 0, v22
    s_cbranch_vccz Levd_114
    s_sleep 1
    s_sub_u32 s77, s77, 1
    s_cbranch_scc1 L_end
    s_branch Lev_113
Levd_114:
    s_setprio 2
    s_lshl_b32 s88, s2, 2
    s_add_u32 s88, s88, s74
    s_mul_i32 s88, s88, 1376
    s_and_b32 s88, s88, 0xffffffc0
    s_add_u32 s90, s26, s88
    s_addc_u32 s91, s27, 0
    s_load_dword s92, s[90:91], 0
    s_load_dword s93, s[90:91], 64
    s_load_dword s94, s[90:91], 128
    s_load_dword s95, s[90:91], 192
    s_load_dword s92, s[90:91], 256
    s_load_dword s93, s[90:91], 320
    s_load_dword s94, s[90:91], 384
    s_load_dword s95, s[90:91], 448
    s_load_dword s92, s[90:91], 512
    s_load_dword s93, s[90:91], 576
    s_load_dword s94, s[90:91], 640
    s_load_dword s95, s[90:91], 704
    s_sleep 10
Lg_115:
    buffer_load_dwordx4 v[32:35], v2, s[44:47], s10 offen sc1
    buffer_load_dwordx4 v[36:39], v2, s[44:47], s10 offen offset:1024 sc1
    buffer_load_dwordx4 v[40:43], v2, s[44:47], s11 offen sc1
    buffer_load_dwordx4 v[44:47], v2, s[44:47], s11 offen offset:1024 sc1
    buffer_load_dwordx4 v[48:51], v16, s[44:47], s6 offen sc1
    buffer_load_dwordx2 v[52:53], v17, s[44:47], s7 offen offset:8 sc1
    s_waitcnt vmcnt(0)
    v_xor_b32 v33, s75, v33
    v_xor_b32 v35, s75, v35
    v_xor_b32 v37, s75, v37
    v_xor_b32 v39, s75, v39
    v_xor_b32 v41, s75, v41
    v_xor_b32 v43, s75, v43
    v_xor_b32 v45, s75, v45
    v_xor_b32 v47, s75, v47
    v_xor_b32 v51, s75, v51
    v_xor_b32 v53, s75, v53
    v_or3_b32 v33, v33, v35, v37
    v_or3_b32 v39, v39, v41, v43
    v_or3_b32 v45, v45, v47, v51
    v_or3_b32 v33, v33, v39, v45
    v_or_b32 v33, v33, v53
    v_cmp_ne_u32 vcc, 0, v33
    s_cbranch_vccz Lgo_116
    s_sub_u32 s77, s77, 1
    s_cbranch_scc1 L_end
    s_branch Lg_115
Lgo_116:
    v_add_f32 v32, v32, v36
    v_add_f32 v34, v34, v38
    v_add_f32 v40, v40, v44
    v_add_f32 v42, v42, v46
    v_cmp_ne_u32 vcc, s78, v52
    v_permlane32_swap_b32 v32, v40
    v_permlane32_swap_b32 v34, v42
    v_add_f32 v32, v32, v40
    v_add_f32 v34, v34, v42
    s_cmp_lg_u64 vcc, 0
    s_cselect_b32 s8, 3, 1
    v_permlane16_swap_b32 v32, v34
    v_add_f32 v32, v32, v34
    v_mov_b32 v61, s8
    v_mul_f32 v48, v48, v49
    v_add_f32_dpp v32, v32, v32 row_ror:8 row_mask:0xf bank_mask:0xf
    v_cvt_pk_bf16_f32 v33, v32, v32
    v_and_b32 v32, 0xffff0000, v33
    v_add_f32 v32, v32, v59
    v_cvt_pk_bf16_f32 v33, v32, v32
    v_and_b32 v32, 0xffff0000, v33
    s_waitcnt lgkmcnt(0)
    ds_write_b32 v58, v32
    ds_write_b8 v5, v61 offset:240
    v_pk_fma_f32 v[96:97], v[96:97], v[48:49], v[48:49] op_sel:[0,1,0] op_sel_hi:[1,1,0] neg_lo:[0,0,1] neg_hi:[0,0,1]
    v_pk_fma_f32 v[98:99], v[98:99], v[48:49], v[48:49] op_sel:[0,1,0] op_sel_hi:[1,1,0] neg_lo:[0,0,1] neg_hi:[0,0,1]
    v_pk_fma_f32 v[100:101], v[100:101], v[48:49], v[48:49] op_sel:[0,1,0] op_sel_hi:[1,1,0] neg_lo:[0,0,1] neg_hi:[0,0,1]
    v_pk_fma_f32 v[102:103], v[102:103], v[48:49], v[48:49] op_sel:[0,1,0] op_sel_hi:[1,1,0] neg_lo:[0,0,1] neg_hi:[0,0,1]
    v_pk_fma_f32 v[104:105], v[104:105], v[48:49], v[48:49] op_sel:[0,1,0] op_sel_hi:[1,1,0] neg_lo:[0,0,1] neg_hi:[0,0,1]
    v_pk_fma_f32 v[106:107], v[106:107], v[48:49], v[48:49] op_sel:[0,1,0] op_sel_hi:[1,1,0] neg_lo:[0,0,1] neg_hi:[0,0,1]
    v_pk_fma_f32 v[108:109], v[108:109], v[48:49], v[48:49] op_sel:[0,1,0] op_sel_hi:[1,1,0] neg_lo:[0,0,1] neg_hi:[0,0,1]
    v_pk_fma_f32 v[110:111], v[110:111], v[48:49], v[48:49] op_sel:[0,1,0] op_sel_hi:[1,1,0] neg_lo:[0,0,1] neg_hi:[0,0,1]
Lm_117:
    ds_read_b32 v32, v6 offset:240
    ds_read_b128 v[64:67], v60 offset:0
    ds_read_b128 v[80:83], v60 offset:256
    ds_read_b128 v[68:71], v60 offset:16
    ds_read_b128 v[84:87], v60 offset:272
    ds_read_b128 v[72:75], v60 offset:64
    ds_read_b128 v[88:91], v60 offset:320
    ds_read_b128 v[76:79], v60 offset:80
    ds_read_b128 v[92:95], v60 offset:336
    s_waitcnt lgkmcnt(8)
    v_readfirstlane_b32 s76, v32
    s_nop 0
    s_and_b32 s8, s76, 0x01010101
    s_cmp_eq_u32 s8, 0x01010101
    s_cbranch_scc1 Lmd_118
    s_waitcnt lgkmcnt(0)
    s_sub_u32 s77, s77, 1
    s_cbranch_scc1 L_end
    s_branch Lm_117
Lmd_118:
    s_and_b32 s76, s76, 0x02020202
    s_waitcnt lgkmcnt(0)
    v_pk_fma_f32 v[96:97], v[96:97], v[80:81], v[64:65]
    v_pk_fma_f32 v[98:99], v[98:99], v[82:83], v[66:67]
    v_pk_fma_f32 v[100:101], v[100:101], v[84:85], v[68:69]
    v_pk_fma_f32 v[102:103], v[102:103], v[86:87], v[70:71]
    v_pk_fma_f32 v[104:105], v[104:105], v[88:89], v[72:73]
    v_pk_fma_f32 v[106:107], v[106:107], v[90:91], v[74:75]
    v_pk_fma_f32 v[108:109], v[108:109], v[92:93], v[76:77]
    v_pk_fma_f32 v[110:111], v[110:111], v[94:95], v[78:79]
    v_cvt_pk_bf16_f32 v40, v96, v97
    v_cvt_pk_bf16_f32 v41, v98, v99
    v_cvt_pk_bf16_f32 v42, v100, v101
    v_cvt_pk_bf16_f32 v43, v102, v103
    v_cvt_pk_bf16_f32 v44, v104, v105
    v_cvt_pk_bf16_f32 v45, v106, v107
    v_cvt_pk_bf16_f32 v46, v108, v109
    v_cvt_pk_bf16_f32 v47, v110, v111
    buffer_store_dwordx4 v[40:43], v2, s[44:47], s3 offen sc1
    buffer_store_dwordx4 v[44:47], v2, s[44:47], s3 offen offset:1024 sc1
    s_waitcnt vmcnt(0)
    s_cmp_lg_u32 s76, 0
    s_cbranch_scc1 Lsafe_119
    buffer_store_dword v14, v15, s[44:47], s5 offen
Lback_120:
    s_setprio 0
    s_load_dword s92, s[90:91], 768
    s_load_dword s93, s[90:91], 832
    s_load_dword s94, s[90:91], 896
    s_load_dword s95, s[90:91], 960
    s_load_dword s92, s[90:91], 1024
    s_load_dword s93, s[90:91], 1088
    s_load_dword s94, s[90:91], 1152
    s_load_dword s95, s[90:91], 1216
    s_load_dword s92, s[90:91], 1280
    s_load_dword s93, s[90:91], 1344
    s_lshl_b32 s88, s2, 2
    s_add_u32 s88, s88, s74
    s_mul_i32 s88, s88, 1376
    s_and_b32 s88, s88, 0xffffffc0
    s_add_u32 s90, s28, s88
    s_addc_u32 s91, s29, 0
    s_load_dword s94, s[90:91], 0
    s_load_dword s95, s[90:91], 64
    s_load_dword s92, s[90:91], 128
    s_load_dword s93, s[90:91], 192
    s_load_dword s94, s[90:91], 256
    s_load_dword s95, s[90:91], 320
    s_load_dword s92, s[90:91], 384
    s_load_dword s93, s[90:91], 448
    s_load_dword s94, s[90:91], 512
    s_load_dword s95, s[90:91], 576
    s_load_dword s92, s[90:91], 640
    s_load_dword s93, s[90:91], 704
    s_load_dword s94, s[90:91], 768
    s_load_dword s95, s[90:91], 832
    s_load_dword s92, s[90:91], 896
    s_load_dword s93, s[90:91], 960
    s_load_dword s94, s[90:91], 1024
    s_load_dword s95, s[90:91], 1088
    s_load_dword s92, s[90:91], 1152
    s_load_dword s93, s[90:91], 1216
    s_load_dword s94, s[90:91], 1280
    s_load_dword s95, s[90:91], 1344
    s_and_b32 s3, s73, 15
    s_lshl_b32 s8, s3, 6
    s_cmp_lt_u32 s3, 11
    s_cselect_b32 s85, 1, 0
    s_mul_i32 s4, s3, 3
    s_lshl_b32 s3, s3, 1
    s_add_u32 s3, s3, 11
    s_min_u32 s79, s3, s4
    s_lshl_b32 s79, s79, 6
    s_lshr_b32 s99, s73, 3
    s_mov_b32 s52, s18
    s_mov_b32 s53, s19
    s_mov_b32 s54, 0x180000
    s_mov_b32 s55, 0x20000
    s_mov_b32 s56, s26
    s_mov_b32 s57, s27
    s_mov_b32 s58, 0x158000
    s_mov_b32 s59, 0x20000
    s_mov_b32 s60, s28
    s_mov_b32 s61, s29
    s_mov_b32 s62, 0x158000
    s_mov_b32 s63, 0x20000
    s_mov_b32 s64, s22
    s_mov_b32 s65, s23
    s_mov_b32 s66, 0x80000
    s_mov_b32 s67, 0x20000
    v_lshrrev_b32 v16, 2, v1
    v_mul_u32_u24 v16, 1024, v16
    v_and_b32 v8, 3, v1
    v_lshl_add_u32 v8, v8, 4, v16
    v_lshrrev_b32 v16, 2, v1
    v_mul_u32_u24 v16, 2752, v16
    v_and_b32 v9, 3, v1
    v_lshl_add_u32 v9, v9, 4, v16
    v_lshrrev_b32 v16, 2, v1
    v_mul_u32_u24 v16, 3072, v16
    v_and_b32 v30, 3, v1
    v_lshl_add_u32 v30, v30, 4, v16
    s_mul_i32 s9, s74, 352256
    s_add_u32 s9, s9, s79
    s_mov_b32 s82, 0x00003f80
    s_mov_b32 s83, 0x3f800000
    s_lshl_b32 s4, s12, 13
    s_lshl_b32 s5, s15, 10
    s_add_u32 s4, s4, s5
    s_lshl_b32 s5, s13, 9
    s_add_u32 s4, s4, s5
    s_add_u32 s90, s40, s4
    s_addc_u32 s91, s41, 0
    s_load_dword s92, s[90:91], 0x80000
    s_load_dword s93, s[90:91], 0x80040
    s_load_dword s94, s[90:91], 0x80080
    s_load_dword s95, s[90:91], 0x800c0
    s_load_dword s92, s[90:91], 0x80100
    s_load_dword s93, s[90:91], 0x80140
    s_load_dword s94, s[90:91], 0x80180
    s_load_dword s95, s[90:91], 0x801c0
    s_lshl_b32 s4, s12, 7
    s_lshl_b32 s5, s13, 6
    s_add_u32 s4, s4, s5
    s_add_u32 s90, s40, s4
    s_addc_u32 s91, s41, 0
    s_load_dword s92, s[90:91], 0x2000
    s_load_dword s93, s[90:91], 0x4000
    s_load_dword s94, s[90:91], 0x6000
    s_load_dword s95, s[90:91], 0x8000
    s_load_dword s92, s[90:91], 0xa000
    v_bfe_u32 v16, v1, 2, 2
    v_lshlrev_b32 v16, 6, v16
    v_and_b32 v17, 3, v1
    v_lshl_add_u32 v16, v17, 3, v16
    v_bfe_u32 v17, v1, 4, 1
    v_lshl_add_u32 v16, v17, 5, v16
    v_lshrrev_b32 v17, 5, v1
    v_lshl_add_u32 v3, v17, 8, v16
    s_lshl_b32 s3, s13, 10
    s_xor_b32 s4, s3, 1024
    v_add_u32 v4, s4, v3
    v_add_u32 v3, s3, v3
    s_lshl_b32 s3, s74, 12
    s_add_u32 s3, s3, 0x22800
    v_add_u32 v11, s3, v2
    s_xor_b32 s4, s74, 2
    s_lshl_b32 s4, s4, 12
    s_add_u32 s4, s4, 0x22800
    v_add_u32 v12, s4, v2
    s_lshl_b32 s3, s13, 16
    s_sub_u32 s3, 0x18000, s3
    v_add_u32 v24, s3, v3
    v_add_u32 v25, s3, v4
    v_permlane32_swap_b32 v112, v114
    v_permlane32_swap_b32 v113, v115
    v_permlane32_swap_b32 v116, v118
    v_permlane32_swap_b32 v117, v119
    v_and_b32 v26, 7, v1
    v_lshlrev_b32 v26, 2, v26
    s_lshl_b32 s3, s12, 7
    s_lshl_b32 s4, s13, 5
    s_add_u32 s3, s3, s4
    s_add_u32 s68, s3, 0x2000
    s_lshl_b32 s5, s12, 15
    s_lshl_b32 s4, s13, 14
    s_add_u32 s5, s5, s4
    s_add_u32 s69, s5, 0x400000
    s_add_u32 s70, s101, 0x200000
    s_lshl_b32 s3, s12, 13
    s_add_u32 s71, s3, 0x80000
    s_lshl_b32 s4, s15, 10
    s_lshl_b32 s5, s13, 3
    s_add_u32 s4, s4, s5
    s_add_u32 s10, s4, s71
    s_lshl_b32 s5, s74, 3
    s_add_u32 s5, s5, s15
    s_lshl_b32 s5, s5, 12
    s_add_u32 s11, s5, 0x40000
    v_lshrrev_b32 v27, 5, v1
    v_lshlrev_b32 v27, 4, v27
    s_lshl_b32 s4, s13, 7
    s_add_u32 s4, s4, 0x20400
    v_add_u32 v27, s4, v27
    v_lshrrev_b32 v21, 4, v1
    v_and_b32 v22, 7, v1
    v_lshlrev_b32 v22, 3, v22
    v_lshl_add_u32 v21, v21, 6, v22
    s_lshl_b32 s3, s74, 8
    s_add_u32 s3, s3, 0x20400
    v_add_u32 v21, s3, v21
    s_lshl_b32 s6, s74, 13
    v_add_u32 v20, s6, v2
    s_mov_b32 s7, s9
    s_waitcnt vmcnt(0)
Lev_121:
    ds_read_b32 v16, v6 offset:448
    s_waitcnt lgkmcnt(0)
    v_readfirstlane_b32 s98, v16
    s_nop 0
    s_cmp_eq_u32 s98, 0x01010101
    s_cbranch_scc1 Levd_122
    s_cmp_lg_u32 s98, 0
    s_cbranch_scc1 Levs_123
    s_sleep 3
Levs_123:
    s_sleep 1
    s_sub_u32 s77, s77, 1
    s_cbranch_scc1 L_end
    s_branch Lev_121
Levd_122:
    s_mul_i32 s3, s74, 393216
    s_add_u32 s3, s3, s8
    s_lshl_b32 s4, s74, 13
    s_add_u32 m0, s4, 0x8000
    s_nop 0
    buffer_load_dwordx4 v30, s[52:55], s3 offen lds
    s_add_u32 s3, s3, 49152
    s_add_u32 m0, s4, 0x8400
    s_nop 0
    buffer_load_dwordx4 v30, s[52:55], s3 offen lds
    s_add_u32 s3, s3, 49152
    s_add_u32 m0, s4, 0x8800
    s_nop 0
    buffer_load_dwordx4 v30, s[52:55], s3 offen lds
    s_add_u32 s3, s3, 49152
    s_add_u32 m0, s4, 0x8c00
    s_nop 0
    buffer_load_dwordx4 v30, s[52:55], s3 offen lds
    s_add_u32 s3, s3, 49152
    s_add_u32 m0, s4, 0x9000
    s_nop 0
    buffer_load_dwordx4 v30, s[52:55], s3 offen lds
    s_add_u32 s3, s3, 49152
    s_add_u32 m0, s4, 0x9400
    s_nop 0
    buffer_load_dwordx4 v30, s[52:55], s3 offen lds
    s_add_u32 s3, s3, 49152
    s_add_u32 m0, s4, 0x9800
    s_nop 0
    buffer_load_dwordx4 v30, s[52:55], s3 offen lds
    s_add_u32 s3, s3, 49152
    s_add_u32 m0, s4, 0x9c00
    s_nop 0
    buffer_load_dwordx4 v30, s[52:55], s3 offen lds
    s_add_u32 s4, s99, 0
    s_and_b32 s4, s4, 3
    s_lshl_b32 s3, s74, 2
    s_add_u32 s4, s4, s3
    s_lshl_b32 s3, s4, 14
    s_lshl_b32 s5, s15, 7
    s_add_u32 s3, s3, s5
    s_lshl_b32 s4, s4, 11
    s_add_u32 m0, s4, 0x18000
    s_waitcnt vmcnt(7)
    buffer_load_dwordx4 v8, s[64:67], s3 offen lds
    s_add_u32 m0, s4, 0x183c0
    s_waitcnt vmcnt(7)
    buffer_load_dwordx4 v8, s[64:67], s3 offen offset:64 lds
    s_add_u32 s4, s99, 1
    s_and_b32 s4, s4, 3
    s_lshl_b32 s3, s74, 2
    s_add_u32 s4, s4, s3
    s_lshl_b32 s3, s4, 14
    s_lshl_b32 s5, s15, 7
    s_add_u32 s3, s3, s5
    s_lshl_b32 s4, s4, 11
    s_add_u32 m0, s4, 0x18000
    s_waitcnt vmcnt(7)
    buffer_load_dwordx4 v8, s[64:67], s3 offen lds
    s_add_u32 m0, s4, 0x183c0
    s_waitcnt vmcnt(7)
    buffer_load_dwordx4 v8, s[64:67], s3 offen offset:64 lds
    s_add_u32 s4, s99, 2
    s_and_b32 s4, s4, 3
    s_lshl_b32 s3, s74, 2
    s_add_u32 s4, s4, s3
    s_lshl_b32 s3, s4, 14
    s_lshl_b32 s5, s15, 7
    s_add_u32 s3, s3, s5
    s_lshl_b32 s4, s4, 11
    s_add_u32 m0, s4, 0x18000
    s_waitcnt vmcnt(7)
    buffer_load_dwordx4 v8, s[64:67], s3 offen lds
    s_add_u32 m0, s4, 0x183c0
    s_waitcnt vmcnt(7)
    buffer_load_dwordx4 v8, s[64:67], s3 offen offset:64 lds
    s_add_u32 s4, s99, 3
    s_and_b32 s4, s4, 3
    s_lshl_b32 s3, s74, 2
    s_add_u32 s4, s4, s3
    s_lshl_b32 s3, s4, 14
    s_lshl_b32 s5, s15, 7
    s_add_u32 s3, s3, s5
    s_lshl_b32 s4, s4, 11
    s_add_u32 m0, s4, 0x18000
    s_waitcnt vmcnt(7)
    buffer_load_dwordx4 v8, s[64:67], s3 offen lds
    s_add_u32 m0, s4, 0x183c0
    s_waitcnt vmcnt(7)
    ds_write_b8 v5, v7 offset:464
    buffer_load_dwordx4 v8, s[64:67], s3 offen offset:64 lds
    buffer_load_dwordx4 v[32:35], v2, s[44:47], s11 offen offset:0 sc1
    buffer_load_dwordx4 v[36:39], v2, s[44:47], s11 offen offset:1024 sc1
    buffer_load_dwordx4 v[40:43], v2, s[44:47], s11 offen offset:2048 sc1
    buffer_load_dwordx4 v[44:47], v2, s[44:47], s11 offen offset:3072 sc1
Lev_124:
    ds_read_b32 v16, v6 offset:16
    s_waitcnt lgkmcnt(0)
    v_readfirstlane_b32 s98, v16
    s_nop 0
    s_cmp_eq_u32 s98, 0x01010101
    s_cbranch_scc1 Levd_125
    s_cmp_lg_u32 s98, 0
    s_cbranch_scc1 Levs_126
    s_sleep 3
Levs_126:
    s_sleep 1
    s_sub_u32 s77, s77, 1
    s_cbranch_scc1 L_end
    s_branch Lev_124
Levd_125:
    s_add_u32 m0, s6, 0x0
    s_waitcnt vmcnt(7)
    buffer_load_dwordx4 v9, s[56:59], s7 offen lds
    s_add_u32 m0, s6, 0xffc0
    s_waitcnt vmcnt(7)
    buffer_load_dwordx4 v9, s[56:59], s7 offen offset:64 lds
    s_waitcnt vmcnt(7)
    buffer_load_dwordx4 v[192:195], v9, s[56:59], s7 offen offset:128
    s_add_u32 s7, s7, 44032
    s_add_u32 m0, s6, 0x400
    s_waitcnt vmcnt(7)
    buffer_load_dwordx4 v9, s[56:59], s7 offen lds
    s_add_u32 m0, s6, 0x103c0
    s_waitcnt vmcnt(7)
    buffer_load_dwordx4 v9, s[56:59], s7 offen offset:64 lds
    s_waitcnt vmcnt(7)
    buffer_load_dwordx4 v[196:199], v9, s[56:59], s7 offen offset:128
    s_add_u32 s7, s7, 44032
    s_add_u32 m0, s6, 0x800
    s_waitcnt vmcnt(7)
    buffer_load_dwordx4 v9, s[56:59], s7 offen lds
    s_add_u32 m0, s6, 0x107c0
    s_waitcnt vmcnt(7)
    buffer_load_dwordx4 v9, s[56:59], s7 offen offset:64 lds
    s_waitcnt vmcnt(7)
    buffer_load_dwordx4 v[200:203], v9, s[56:59], s7 offen offset:128
    s_add_u32 s7, s7, 44032
    s_add_u32 m0, s6, 0xc00
    s_waitcnt vmcnt(7)
    buffer_load_dwordx4 v9, s[56:59], s7 offen lds
    s_add_u32 m0, s6, 0x10bc0
    s_waitcnt vmcnt(7)
    buffer_load_dwordx4 v9, s[56:59], s7 offen offset:64 lds
    s_waitcnt vmcnt(7)
    buffer_load_dwordx4 v[204:207], v9, s[56:59], s7 offen offset:128
    s_add_u32 s7, s7, 44032
    s_add_u32 m0, s6, 0x1000
    s_waitcnt vmcnt(7)
    buffer_load_dwordx4 v9, s[56:59], s7 offen lds
    s_add_u32 m0, s6, 0x10fc0
    s_waitcnt vmcnt(7)
    buffer_load_dwordx4 v9, s[56:59], s7 offen offset:64 lds
    s_waitcnt vmcnt(7)
    buffer_load_dwordx4 v[208:211], v9, s[56:59], s7 offen offset:128
    s_add_u32 s7, s7, 44032
    s_add_u32 m0, s6, 0x1400
    s_waitcnt vmcnt(7)
    buffer_load_dwordx4 v9, s[56:59], s7 offen lds
    s_add_u32 m0, s6, 0x113c0
    s_waitcnt vmcnt(7)
    buffer_load_dwordx4 v9, s[56:59], s7 offen offset:64 lds
    s_waitcnt vmcnt(7)
    buffer_load_dwordx4 v[212:215], v9, s[56:59], s7 offen offset:128
    s_add_u32 s7, s7, 44032
    s_add_u32 m0, s6, 0x1800
    s_waitcnt vmcnt(7)
    buffer_load_dwordx4 v9, s[56:59], s7 offen lds
    s_add_u32 m0, s6, 0x117c0
    s_waitcnt vmcnt(7)
    buffer_load_dwordx4 v9, s[56:59], s7 offen offset:64 lds
    s_waitcnt vmcnt(7)
    buffer_load_dwordx4 v[216:219], v9, s[56:59], s7 offen offset:128
    s_add_u32 s7, s7, 44032
    s_add_u32 m0, s6, 0x1c00
    s_waitcnt vmcnt(7)
    buffer_load_dwordx4 v9, s[56:59], s7 offen lds
    s_add_u32 m0, s6, 0x11bc0
    s_waitcnt vmcnt(7)
    buffer_load_dwordx4 v9, s[56:59], s7 offen offset:64 lds
    s_waitcnt vmcnt(7)
    buffer_load_dwordx4 v[220:223], v9, s[56:59], s7 offen offset:128
Lev_127:
    ds_read_b32 v16, v6 offset:48
    s_waitcnt lgkmcnt(0)
    v_readfirstlane_b32 s98, v16
    s_nop 0
    s_cmp_eq_u32 s98, 0x01010101
    s_cbranch_scc1 Levd_128
    s_cmp_lg_u32 s98, 0
    s_cbranch_scc1 Levs_129
    s_sleep 3
Levs_129:
    s_sleep 1
    s_sub_u32 s77, s77, 1
    s_cbranch_scc1 L_end
    s_branch Lev_127
Levd_128:
    s_add_u32 s4, s99, 0
    s_and_b32 s4, s4, 3
    s_lshl_b32 s3, s74, 2
    s_add_u32 s4, s4, s3
    s_lshl_b32 s3, s4, 14
    s_lshl_b32 s5, s15, 7
    s_add_u32 s3, s3, s5
    s_add_u32 s3, s3, 0x40000
    s_lshl_b32 s4, s4, 11
    s_add_u32 m0, s4, 0x8000
    s_waitcnt vmcnt(7)
    buffer_load_dwordx4 v8, s[64:67], s3 offen lds
    s_add_u32 m0, s4, 0x83c0
    s_waitcnt vmcnt(7)
    buffer_load_dwordx4 v8, s[64:67], s3 offen offset:64 lds
    s_add_u32 s4, s99, 1
    s_and_b32 s4, s4, 3
    s_lshl_b32 s3, s74, 2
    s_add_u32 s4, s4, s3
    s_lshl_b32 s3, s4, 14
    s_lshl_b32 s5, s15, 7
    s_add_u32 s3, s3, s5
    s_add_u32 s3, s3, 0x40000
    s_lshl_b32 s4, s4, 11
    s_add_u32 m0, s4, 0x8000
    s_waitcnt vmcnt(7)
    buffer_load_dwordx4 v8, s[64:67], s3 offen lds
    s_add_u32 m0, s4, 0x83c0
    s_waitcnt vmcnt(7)
    buffer_load_dwordx4 v8, s[64:67], s3 offen offset:64 lds
    s_add_u32 s4, s99, 2
    s_and_b32 s4, s4, 3
    s_lshl_b32 s3, s74, 2
    s_add_u32 s4, s4, s3
    s_lshl_b32 s3, s4, 14
    s_lshl_b32 s5, s15, 7
    s_add_u32 s3, s3, s5
    s_add_u32 s3, s3, 0x40000
    s_lshl_b32 s4, s4, 11
    s_add_u32 m0, s4, 0x8000
    s_waitcnt vmcnt(7)
    buffer_load_dwordx4 v8, s[64:67], s3 offen lds
    s_add_u32 m0, s4, 0x83c0
    s_waitcnt vmcnt(7)
    buffer_load_dwordx4 v8, s[64:67], s3 offen offset:64 lds
    s_add_u32 s4, s99, 3
    s_and_b32 s4, s4, 3
    s_lshl_b32 s3, s74, 2
    s_add_u32 s4, s4, s3
    s_lshl_b32 s3, s4, 14
    s_lshl_b32 s5, s15, 7
    s_add_u32 s3, s3, s5
    s_add_u32 s3, s3, 0x40000
    s_lshl_b32 s4, s4, 11
    s_add_u32 m0, s4, 0x8000
    s_waitcnt vmcnt(7)
    buffer_load_dwordx4 v8, s[64:67], s3 offen lds
    s_add_u32 m0, s4, 0x83c0
    s_waitcnt vmcnt(7)
    buffer_load_dwordx4 v8, s[64:67], s3 offen offset:64 lds
    s_waitcnt vmcnt(7)
    buffer_load_dwordx4 v[128:131], v9, s[60:63], s9 offen offset:0
    s_waitcnt vmcnt(7)
    buffer_load_dwordx4 v[160:163], v9, s[60:63], s9 offen offset:64
    s_waitcnt vmcnt(7)
    buffer_load_dwordx4 v[224:227], v9, s[60:63], s9 offen offset:128
    s_add_u32 s9, s9, 44032
    s_waitcnt vmcnt(7)
    buffer_load_dwordx4 v[132:135], v9, s[60:63], s9 offen offset:0
    s_waitcnt vmcnt(7)
    buffer_load_dwordx4 v[164:167], v9, s[60:63], s9 offen offset:64
    s_waitcnt vmcnt(7)
    buffer_load_dwordx4 v[228:231], v9, s[60:63], s9 offen offset:128
    s_add_u32 s9, s9, 44032
    s_waitcnt vmcnt(7)
    buffer_load_dwordx4 v[136:139], v9, s[60:63], s9 offen offset:0
    s_waitcnt vmcnt(7)
    buffer_load_dwordx4 v[168:171], v9, s[60:63], s9 offen offset:64
    s_waitcnt vmcnt(7)
    buffer_load_dwordx4 v[232:235], v9, s[60:63], s9 offen offset:128
    s_add_u32 s9, s9, 44032
    s_waitcnt vmcnt(7)
    buffer_load_dwordx4 v[140:143], v9, s[60:63], s9 offen offset:0
    s_waitcnt vmcnt(7)
    buffer_load_dwordx4 v[172:175], v9, s[60:63], s9 offen offset:64
    s_waitcnt vmcnt(7)
    buffer_load_dwordx4 v[236:239], v9, s[60:63], s9 offen offset:128
    s_add_u32 s9, s9, 44032
    s_waitcnt vmcnt(7)
    buffer_load_dwordx4 v[144:147], v9, s[60:63], s9 offen offset:0
    s_waitcnt vmcnt(7)
    buffer_load_dwordx4 v[176:179], v9, s[60:63], s9 offen offset:64
    s_waitcnt vmcnt(7)
    buffer_load_dwordx4 v[240:243], v9, s[60:63], s9 offen offset:128
    s_add_u32 s9, s9, 44032
    s_waitcnt vmcnt(7)
    buffer_load_dwordx4 v[148:151], v9, s[60:63], s9 offen offset:0
    s_waitcnt vmcnt(7)
    buffer_load_dwordx4 v[180:183], v9, s[60:63], s9 offen offset:64
    s_waitcnt vmcnt(7)
    buffer_load_dwordx4 v[244:247], v9, s[60:63], s9 offen offset:128
    s_add_u32 s9, s9, 44032
Lg_130:
    v_xor_b32 v33, s75, v33
    v_xor_b32 v35, s75, v35
    v_xor_b32 v37, s75, v37
    v_xor_b32 v39, s75, v39
    v_xor_b32 v41, s75, v41
    v_xor_b32 v43, s75, v43
    v_xor_b32 v45, s75, v45
    v_xor_b32 v47, s75, v47
    v_or_b32 v33, v33, v47
    v_or3_b32 v33, v33, v35, v37
    v_or3_b32 v33, v33, v39, v41
    v_or3_b32 v33, v33, v43, v45
    v_cmp_ne_u32 vcc, 0, v33
    s_cbranch_vccz Lgo_131
    buffer_load_dwordx4 v[32:35], v2, s[44:47], s11 offen offset:0 sc1
    buffer_load_dwordx4 v[36:39], v2, s[44:47], s11 offen offset:1024 sc1
    buffer_load_dwordx4 v[40:43], v2, s[44:47], s11 offen offset:2048 sc1
    buffer_load_dwordx4 v[44:47], v2, s[44:47], s11 offen offset:3072 sc1
    s_waitcnt vmcnt(0)
    s_sleep 2
    s_sub_u32 s77, s77, 1
    s_cbranch_scc1 L_end
    s_branch Lg_130
Lgo_131:
    v_permlane32_swap_b32 v32, v40
    v_permlane32_swap_b32 v34, v42
    v_permlane32_swap_b32 v36, v44
    v_permlane32_swap_b32 v38, v46
    v_add_f32 v32, v32, v40
    v_add_f32 v34, v34, v42
    v_add_f32 v36, v36, v44
    v_add_f32 v38, v38, v46
    s_nop 0
    v_permlane16_swap_b32 v32, v36
    v_permlane16_swap_b32 v34, v38
    v_add_f32 v32, v32, v36
    v_add_f32 v33, v34, v38
    s_nop 0
    v_add_f32_dpp v32, v32, v32 row_ror:8 row_mask:0xf bank_mask:0xf
    v_add_f32_dpp v33, v33, v33 row_ror:8 row_mask:0xf bank_mask:0xf
    s_cmp_eq_u32 s74, 2
    s_cselect_b32 s3, 1.0, 0
    v_cvt_pk_bf16_f32 v34, v32, v32
    v_and_b32 v32, 0xffff0000, v34
    v_add_f32 v32, s3, v32
    v_cvt_pk_bf16_f32 v34, v32, v32
    v_and_b32 v32, 0xffff0000, v34
    v_cvt_pk_bf16_f32 v34, v33, v33
    v_and_b32 v33, 0xffff0000, v34
    v_add_f32 v33, s3, v33
    v_cvt_pk_bf16_f32 v34, v33, v33
    v_and_b32 v33, 0xffff0000, v34
    ds_write_b64 v21, v[32:33]
    ds_write_b8 v5, v7 offset:80
    s_mov_b32 s64, s30
    s_mov_b32 s65, s31
    s_mov_b32 s66, 0x158000
    s_mov_b32 s67, 0x20000
Lev_132:
    ds_read_b32 v16, v6 offset:80
    s_waitcnt lgkmcnt(0)
    v_readfirstlane_b32 s98, v16
    s_nop 0
    s_cmp_eq_u32 s98, 0x01010101
    s_cbranch_scc1 Levd_133
    s_sub_u32 s77, s77, 1
    s_cbranch_scc1 L_end
    s_branch Lev_132
Levd_133:
    buffer_load_dword v18, v26, s[44:47], s68 offen sc1
    s_sleep 2
Lpf_134:
    buffer_load_dword v19, v26, s[44:47], s68 offen sc1
    s_waitcnt vmcnt(1)
    v_cmp_ne_u32 vcc, s75, v18
    s_cbranch_vccz Lpfd_135
    buffer_load_dword v18, v26, s[44:47], s68 offen sc1
    s_waitcnt vmcnt(1)
    v_cmp_ne_u32 vcc, s75, v19
    s_cbranch_vccz Lpfd_135
    s_sub_u32 s77, s77, 1
    s_cbranch_scc1 L_end
    s_branch Lpf_134
Lpfd_135:
    s_setprio 2
    buffer_load_dwordx4 v[56:59], v2, s[44:47], s69 offen offset:0 sc1
    buffer_load_dwordx4 v[60:63], v2, s[44:47], s69 offen offset:1024 sc1
    buffer_load_dwordx4 v[96:99], v2, s[44:47], s69 offen offset:2048 sc1
    buffer_load_dwordx4 v[100:103], v2, s[44:47], s69 offen offset:3072 sc1
    s_add_u32 s69, s69, 4096
    buffer_load_dwordx4 v[104:107], v2, s[44:47], s69 offen offset:0 sc1
    buffer_load_dwordx4 v[108:111], v2, s[44:47], s69 offen offset:1024 sc1
    buffer_load_dwordx4 v[120:123], v2, s[44:47], s69 offen offset:2048 sc1
    buffer_load_dwordx4 v[124:127], v2, s[44:47], s69 offen offset:3072 sc1
    ds_read_b64_tr_b16 v[32:33], v25 offset:0
    ds_read_b64_tr_b16 v[34:35], v25 offset:512
    ds_read_b64_tr_b16 v[36:37], v24 offset:0
    ds_read_b64_tr_b16 v[38:39], v24 offset:512
    ds_read_b64_tr_b16 v[40:41], v25 offset:2048
    ds_read_b64_tr_b16 v[42:43], v25 offset:2560
    ds_read_b64_tr_b16 v[44:45], v24 offset:2048
    ds_read_b64_tr_b16 v[46:47], v24 offset:2560
    s_waitcnt vmcnt(7)
    s_waitcnt lgkmcnt(6)
    v_mfma_f32_32x32x16_bf16 v[80:95], v[32:35], v[56:59], 0
    ds_read_b64_tr_b16 v[48:49], v25 offset:4096
    ds_read_b64_tr_b16 v[50:51], v25 offset:4608
    s_waitcnt lgkmcnt(6)
    v_mfma_f32_32x32x16_bf16 v[64:79], v[36:39], v[56:59], 0
    ds_read_b64_tr_b16 v[52:53], v24 offset:4096
    ds_read_b64_tr_b16 v[54:55], v24 offset:4608
    s_add_u32 s69, s69, 4096
    buffer_load_dwordx4 v[56:59], v2, s[44:47], s69 offen offset:0 sc1
    s_waitcnt vmcnt(7)
    s_waitcnt lgkmcnt(6)
    v_mfma_f32_32x32x16_bf16 v[80:95], v[40:43], v[60:63], v[80:95]
    ds_read_b64_tr_b16 v[32:33], v25 offset:6144
    ds_read_b64_tr_b16 v[34:35], v25 offset:6656
    s_waitcnt lgkmcnt(6)
    v_mfma_f32_32x32x16_bf16 v[64:79], v[44:47], v[60:63], v[64:79]
    ds_read_b64_tr_b16 v[36:37], v24 offset:6144
    ds_read_b64_tr_b16 v[38:39], v24 offset:6656
    buffer_load_dwordx4 v[60:63], v2, s[44:47], s69 offen offset:1024 sc1
    s_waitcnt vmcnt(7)
    s_waitcnt lgkmcnt(6)
    v_mfma_f32_32x32x16_bf16 v[80:95], v[48:51], v[96:99], v[80:95]
    ds_read_b64_tr_b16 v[40:41], v25 offset:8192
    ds_read_b64_tr_b16 v[42:43], v25 offset:8704
    s_waitcnt lgkmcnt(6)
    v_mfma_f32_32x32x16_bf16 v[64:79], v[52:55], v[96:99], v[64:79]
    ds_read_b64_tr_b16 v[44:45], v24 offset:8192
    ds_read_b64_tr_b16 v[46:47], v24 offset:8704
    buffer_load_dwordx4 v[96:99], v2, s[44:47], s69 offen offset:2048 sc1
    s_waitcnt vmcnt(7)
    s_waitcnt lgkmcnt(6)
    v_mfma_f32_32x32x16_bf16 v[80:95], v[32:35], v[100:103], v[80:95]
    ds_read_b64_tr_b16 v[48:49], v25 offset:10240
    ds_read_b64_tr_b16 v[50:51], v25 offset:10752
    s_waitcnt lgkmcnt(6)
    v_mfma_f32_32x32x16_bf16 v[64:79], v[36:39], v[100:103], v[64:79]
    ds_read_b64_tr_b16 v[52:53], v24 offset:10240
    ds_read_b64_tr_b16 v[54:55], v24 offset:10752
    buffer_load_dwordx4 v[100:103], v2, s[44:47], s69 offen offset:3072 sc1
    s_waitcnt vmcnt(7)
    s_waitcnt lgkmcnt(6)
    v_mfma_f32_32x32x16_bf16 v[80:95], v[40:43], v[104:107], v[80:95]
    ds_read_b64_tr_b16 v[32:33], v25 offset:12288
    ds_read_b64_tr_b16 v[34:35], v25 offset:12800
    s_waitcnt lgkmcnt(6)
    v_mfma_f32_32x32x16_bf16 v[64:79], v[44:47], v[104:107], v[64:79]
    ds_read_b64_tr_b16 v[36:37], v24 offset:12288
    ds_read_b64_tr_b16 v[38:39], v24 offset:12800
    s_add_u32 s69, s69, 4096
    buffer_load_dwordx4 v[104:107], v2, s[44:47], s69 offen offset:0 sc1
    s_waitcnt vmcnt(7)
    s_waitcnt lgkmcnt(6)
    v_mfma_f32_32x32x16_bf16 v[80:95], v[48:51], v[108:111], v[80:95]
    ds_read_b64_tr_b16 v[40:41], v25 offset:14336
    ds_read_b64_tr_b16 v[42:43], v25 offset:14848
    s_waitcnt lgkmcnt(6)
    v_mfma_f32_32x32x16_bf16 v[64:79], v[52:55], v[108:111], v[64:79]
    ds_read_b64_tr_b16 v[44:45], v24 offset:14336
    ds_read_b64_tr_b16 v[46:47], v24 offset:14848
    buffer_load_dwordx4 v[108:111], v2, s[44:47], s69 offen offset:1024 sc1
    s_waitcnt vmcnt(7)
    s_waitcnt lgkmcnt(6)
    v_mfma_f32_32x32x16_bf16 v[80:95], v[32:35], v[120:123], v[80:95]
    ds_read_b64_tr_b16 v[48:49], v25 offset:16384
    ds_read_b64_tr_b16 v[50:51], v25 offset:16896
    s_waitcnt lgkmcnt(6)
    v_mfma_f32_32x32x16_bf16 v[64:79], v[36:39], v[120:123], v[64:79]
    ds_read_b64_tr_b16 v[52:53], v24 offset:16384
    ds_read_b64_tr_b16 v[54:55], v24 offset:16896
    buffer_load_dwordx4 v[120:123], v2, s[44:47], s69 offen offset:2048 sc1
    s_waitcnt vmcnt(7)
    s_waitcnt lgkmcnt(6)
    v_mfma_f32_32x32x16_bf16 v[80:95], v[40:43], v[124:127], v[80:95]
    ds_read_b64_tr_b16 v[32:33], v25 offset:18432
    ds_read_b64_tr_b16 v[34:35], v25 offset:18944
    s_waitcnt lgkmcnt(6)
    v_mfma_f32_32x32x16_bf16 v[64:79], v[44:47], v[124:127], v[64:79]
    ds_read_b64_tr_b16 v[36:37], v24 offset:18432
    ds_read_b64_tr_b16 v[38:39], v24 offset:18944
    buffer_load_dwordx4 v[124:127], v2, s[44:47], s69 offen offset:3072 sc1
    buffer_load_dword v23, v31, s[44:47], s70 offen
    s_waitcnt vmcnt(8)
    s_waitcnt lgkmcnt(6)
    v_mfma_f32_32x32x16_bf16 v[80:95], v[48:51], v[56:59], v[80:95]
    ds_read_b64_tr_b16 v[40:41], v25 offset:20480
    ds_read_b64_tr_b16 v[42:43], v25 offset:20992
    s_waitcnt lgkmcnt(6)
    v_mfma_f32_32x32x16_bf16 v[64:79], v[52:55], v[56:59], v[64:79]
    ds_read_b64_tr_b16 v[44:45], v24 offset:20480
    ds_read_b64_tr_b16 v[46:47], v24 offset:20992
    buffer_load_dwordx4 v[152:155], v9, s[60:63], s9 offen offset:0
    buffer_load_dwordx4 v[184:187], v9, s[60:63], s9 offen offset:64
    buffer_load_dwordx4 v[248:251], v9, s[60:63], s9 offen offset:128
    s_add_u32 s9, s9, 44032
    s_waitcnt vmcnt(10)
    s_waitcnt lgkmcnt(6)
    v_mfma_f32_32x32x16_bf16 v[80:95], v[32:35], v[60:63], v[80:95]
    ds_read_b64_tr_b16 v[48:49], v25 offset:22528
    ds_read_b64_tr_b16 v[50:51], v25 offset:23040
    s_waitcnt lgkmcnt(6)
    v_mfma_f32_32x32x16_bf16 v[64:79], v[36:39], v[60:63], v[64:79]
    ds_read_b64_tr_b16 v[52:53], v24 offset:22528
    ds_read_b64_tr_b16 v[54:55], v24 offset:23040
    buffer_load_dwordx4 v[156:159], v9, s[60:63], s9 offen offset:0
    buffer_load_dwordx4 v[188:191], v9, s[60:63], s9 offen offset:64
    buffer_load_dwordx4 v[252:255], v9, s[60:63], s9 offen offset:128
    s_waitcnt vmcnt(12)
    s_waitcnt lgkmcnt(6)
    v_mfma_f32_32x32x16_bf16 v[80:95], v[40:43], v[96:99], v[80:95]
    ds_read_b64_tr_b16 v[32:33], v25 offset:24576
    ds_read_b64_tr_b16 v[34:35], v25 offset:25088
    s_waitcnt lgkmcnt(6)
    v_mfma_f32_32x32x16_bf16 v[64:79], v[44:47], v[96:99], v[64:79]
    ds_read_b64_tr_b16 v[36:37], v24 offset:24576
    ds_read_b64_tr_b16 v[38:39], v24 offset:25088
    s_waitcnt vmcnt(11)
    s_waitcnt lgkmcnt(6)
    v_mfma_f32_32x32x16_bf16 v[80:95], v[48:51], v[100:103], v[80:95]
    ds_read_b64_tr_b16 v[40:41], v25 offset:26624
    ds_read_b64_tr_b16 v[42:43], v25 offset:27136
    s_waitcnt lgkmcnt(6)
    v_mfma_f32_32x32x16_bf16 v[64:79], v[52:55], v[100:103], v[64:79]
    ds_read_b64_tr_b16 v[44:45], v24 offset:26624
    ds_read_b64_tr_b16 v[46:47], v24 offset:27136
    s_waitcnt vmcnt(10)
    s_waitcnt lgkmcnt(6)
    v_mfma_f32_32x32x16_bf16 v[80:95], v[32:35], v[104:107], v[80:95]
    ds_read_b64_tr_b16 v[48:49], v25 offset:28672
    ds_read_b64_tr_b16 v[50:51], v25 offset:29184
    s_waitcnt lgkmcnt(6)
    v_mfma_f32_32x32x16_bf16 v[64:79], v[36:39], v[104:107], v[64:79]
    ds_read_b64_tr_b16 v[52:53], v24 offset:28672
    ds_read_b64_tr_b16 v[54:55], v24 offset:29184
    s_waitcnt vmcnt(9)
    s_waitcnt lgkmcnt(6)
    v_mfma_f32_32x32x16_bf16 v[80:95], v[40:43], v[108:111], v[80:95]
    ds_read_b64_tr_b16 v[32:33], v25 offset:30720
    ds_read_b64_tr_b16 v[34:35], v25 offset:31232
    s_waitcnt lgkmcnt(6)
    v_mfma_f32_32x32x16_bf16 v[64:79], v[44:47], v[108:111], v[64:79]
    ds_read_b64_tr_b16 v[36:37], v24 offset:30720
    ds_read_b64_tr_b16 v[38:39], v24 offset:31232
    ds_write_b8 v5, v7 offset:96
    s_waitcnt vmcnt(8)
    s_waitcnt lgkmcnt(7)
    v_mfma_f32_32x32x16_bf16 v[80:95], v[48:51], v[120:123], v[80:95]
    s_waitcnt lgkmcnt(5)
    v_mfma_f32_32x32x16_bf16 v[64:79], v[52:55], v[120:123], v[64:79]
    s_waitcnt vmcnt(7)
    s_waitcnt lgkmcnt(3)
    v_mfma_f32_32x32x16_bf16 v[80:95], v[32:35], v[124:127], v[80:95]
    s_waitcnt lgkmcnt(1)
    v_mfma_f32_32x32x16_bf16 v[64:79], v[36:39], v[124:127], v[64:79]
    v_lshlrev_b32 v96, 16, v112
    v_and_b32 v97, 0xffff0000, v112
    v_lshlrev_b32 v98, 16, v113
    v_and_b32 v99, 0xffff0000, v113
    v_lshlrev_b32 v100, 16, v114
    v_and_b32 v101, 0xffff0000, v114
    v_lshlrev_b32 v102, 16, v115
    v_and_b32 v103, 0xffff0000, v115
    v_lshlrev_b32 v104, 16, v116
    v_and_b32 v105, 0xffff0000, v116
    ds_write_b128 v11, v[80:83] offset:0
    ds_write_b128 v11, v[84:87] offset:1024
    ds_write_b128 v11, v[88:91] offset:2048
    ds_write_b128 v11, v[92:95] offset:3072
    ds_write_b8 v5, v7 offset:208
    ds_read_b128 v[32:35], v27 offset:0
    ds_read_b128 v[36:39], v27 offset:32
    ds_read_b128 v[40:43], v27 offset:64
    ds_read_b128 v[44:47], v27 offset:96
    v_lshlrev_b32 v106, 16, v117
    v_and_b32 v107, 0xffff0000, v117
    v_lshlrev_b32 v108, 16, v118
    v_and_b32 v109, 0xffff0000, v118
    v_lshlrev_b32 v110, 16, v119
    v_and_b32 v111, 0xffff0000, v119
Lx_136:
    ds_read_u8 v16, v13 offset:208
    ds_read_b128 v[80:83], v12 offset:0
    ds_read_b128 v[84:87], v12 offset:1024
    ds_read_b128 v[88:91], v12 offset:2048
    ds_read_b128 v[92:95], v12 offset:3072
    s_waitcnt lgkmcnt(4)
    v_cmp_eq_u32 vcc, 0, v16
    s_cbranch_vccz Lxd_137
    s_sub_u32 s77, s77, 1
    s_cbranch_scc1 L_end
    s_branch Lx_136
Lxd_137:
    s_waitcnt lgkmcnt(3)
    v_pk_add_f32 v[64:65], v[64:65], v[80:81]
    v_pk_add_f32 v[66:67], v[66:67], v[82:83]
    s_waitcnt lgkmcnt(2)
    v_pk_add_f32 v[68:69], v[68:69], v[84:85]
    v_pk_add_f32 v[70:71], v[70:71], v[86:87]
    s_waitcnt lgkmcnt(1)
    v_pk_add_f32 v[72:73], v[72:73], v[88:89]
    v_pk_add_f32 v[74:75], v[74:75], v[90:91]
    s_waitcnt lgkmcnt(0)
    v_pk_add_f32 v[76:77], v[76:77], v[92:93]
    v_pk_add_f32 v[78:79], v[78:79], v[94:95]
    v_pk_fma_f32 v[96:97], v[64:65], v[32:33], v[96:97]
    v_pk_fma_f32 v[98:99], v[66:67], v[34:35], v[98:99]
    v_pk_fma_f32 v[100:101], v[68:69], v[36:37], v[100:101]
    v_pk_fma_f32 v[102:103], v[70:71], v[38:39], v[102:103]
    v_pk_fma_f32 v[104:105], v[72:73], v[40:41], v[104:105]
    v_pk_fma_f32 v[106:107], v[74:75], v[42:43], v[106:107]
    v_pk_fma_f32 v[108:109], v[76:77], v[44:45], v[108:109]
    v_pk_fma_f32 v[110:111], v[78:79], v[46:47], v[110:111]
    v_pk_add_f32 v[120:121], v[96:97], v[98:99]
    v_pk_mul_f32 v[122:123], v[96:97], v[96:97]
    v_pk_fma_f32 v[122:123], v[98:99], v[98:99], v[122:123]
    v_pk_add_f32 v[120:121], v[120:121], v[100:101]
    v_pk_fma_f32 v[122:123], v[100:101], v[100:101], v[122:123]
    v_pk_add_f32 v[120:121], v[120:121], v[102:103]
    v_pk_fma_f32 v[122:123], v[102:103], v[102:103], v[122:123]
    v_pk_add_f32 v[120:121], v[120:121], v[104:105]
    v_pk_fma_f32 v[122:123], v[104:105], v[104:105], v[122:123]
    v_pk_add_f32 v[120:121], v[120:121], v[106:107]
    v_pk_fma_f32 v[122:123], v[106:107], v[106:107], v[122:123]
    v_pk_add_f32 v[120:121], v[120:121], v[108:109]
    v_pk_fma_f32 v[122:123], v[108:109], v[108:109], v[122:123]
    v_pk_add_f32 v[120:121], v[120:121], v[110:111]
    v_pk_fma_f32 v[122:123], v[110:111], v[110:111], v[122:123]
    v_add_f32 v120, v120, v121
    v_add_f32 v122, v122, v123
    v_mov_b32 v121, s75
    s_nop 0
    v_permlane32_swap_b32 v120, v122
    v_add_f32 v120, v120, v122
    s_cmp_lg_u32 s76, 0
    s_cbranch_scc1 Lsafe_138
    buffer_store_dwordx2 v[120:121], v2, s[44:47], s10 offen
Lback_139:
    ds_read_b128 v[48:51], v27 offset:256
    ds_read_b128 v[52:55], v27 offset:288
    ds_read_b128 v[56:59], v27 offset:320
    ds_read_b128 v[60:63], v27 offset:352
    ds_read_b128 v[32:35], v27 offset:512
    ds_read_b128 v[36:39], v27 offset:544
    ds_read_b128 v[40:43], v27 offset:576
    ds_read_b128 v[44:47], v27 offset:608
    s_waitcnt vmcnt(1)
Lev_140:
    ds_read_b32 v16, v6 offset:96
    s_waitcnt lgkmcnt(0)
    v_readfirstlane_b32 s98, v16
    s_nop 0
    s_cmp_eq_u32 s98, 0x01010101
    s_cbranch_scc1 Levd_141
    s_sub_u32 s77, s77, 1
    s_cbranch_scc1 L_end
    s_branch Lev_140
Levd_141:
    ds_write_b128 v20, v[128:131] offset:32768
    ds_write_b128 v20, v[132:135] offset:33792
    ds_write_b128 v20, v[136:139] offset:34816
    ds_write_b128 v20, v[140:143] offset:35840
    ds_write_b128 v20, v[144:147] offset:36864
    ds_write_b128 v20, v[148:151] offset:37888
    ds_write_b128 v20, v[152:155] offset:38912
    ds_write_b128 v20, v[156:159] offset:39936
    ds_write_b8 v5, v7 offset:112
Lg_142:
    s_mov_b32 s4, s71
    buffer_load_dwordx4 v[64:67], v2, s[44:47], s4 offen offset:0 sc1
    buffer_load_dwordx4 v[68:71], v2, s[44:47], s4 offen offset:1024 sc1
    buffer_load_dwordx4 v[72:75], v2, s[44:47], s4 offen offset:2048 sc1
    buffer_load_dwordx4 v[76:79], v2, s[44:47], s4 offen offset:3072 sc1
    s_add_u32 s4, s4, 4096
    buffer_load_dwordx4 v[80:83], v2, s[44:47], s4 offen offset:0 sc1
    buffer_load_dwordx4 v[84:87], v2, s[44:47], s4 offen offset:1024 sc1
    buffer_load_dwordx4 v[88:91], v2, s[44:47], s4 offen offset:2048 sc1
    buffer_load_dwordx4 v[92:95], v2, s[44:47], s4 offen offset:3072 sc1
    v_mov_b32 v124, 0
    v_mov_b32 v125, 0
    s_waitcnt vmcnt(7)
    v_add_f32 v64, v64, v66
    v_bitop3_b32 v125, v65, s75, v125 bitop3:0xbe
    v_add_f32 v124, v124, v64
    v_bitop3_b32 v125, v67, s75, v125 bitop3:0xbe
    s_waitcnt vmcnt(6)
    v_add_f32 v68, v68, v70
    v_bitop3_b32 v125, v69, s75, v125 bitop3:0xbe
    v_add_f32 v124, v124, v68
    v_bitop3_b32 v125, v71, s75, v125 bitop3:0xbe
    s_waitcnt vmcnt(5)
    v_add_f32 v72, v72, v74
    v_bitop3_b32 v125, v73, s75, v125 bitop3:0xbe
    v_add_f32 v124, v124, v72
    v_bitop3_b32 v125, v75, s75, v125 bitop3:0xbe
    s_waitcnt vmcnt(4)
    v_add_f32 v76, v76, v78
    v_bitop3_b32 v125, v77, s75, v125 bitop3:0xbe
    v_add_f32 v124, v124, v76
    v_bitop3_b32 v125, v79, s75, v125 bitop3:0xbe
    s_waitcnt vmcnt(3)
    v_add_f32 v80, v80, v82
    v_bitop3_b32 v125, v81, s75, v125 bitop3:0xbe
    v_add_f32 v124, v124, v80
    v_bitop3_b32 v125, v83, s75, v125 bitop3:0xbe
    s_waitcnt vmcnt(2)
    v_add_f32 v84, v84, v86
    v_bitop3_b32 v125, v85, s75, v125 bitop3:0xbe
    v_add_f32 v124, v124, v84
    v_bitop3_b32 v125, v87, s75, v125 bitop3:0xbe
    s_waitcnt vmcnt(1)
    v_add_f32 v88, v88, v90
    v_bitop3_b32 v125, v89, s75, v125 bitop3:0xbe
    v_add_f32 v124, v124, v88
    v_bitop3_b32 v125, v91, s75, v125 bitop3:0xbe
    s_waitcnt vmcnt(0)
    v_add_f32 v92, v92, v94
    v_bitop3_b32 v125, v93, s75, v125 bitop3:0xbe
    v_add_f32 v124, v124, v92
    v_bitop3_b32 v125, v95, s75, v125 bitop3:0xbe
    v_mul_f32 v124, 0.001953125, v124
    v_cmp_ne_u32 vcc, 0, v125
    v_mov_b32 v125, v124
    s_cbranch_vccz Lgo_143
    s_sub_u32 s77, s77, 1
    s_cbranch_scc1 L_end
    s_branch Lg_142
Lgo_143:
    s_nop 0
    v_permlane32_swap_b32 v124, v125
    v_fma_f32 v125, -v124, v124, v125
    v_max_f32 v125, 0, v125
    v_add_f32 v125, 0x3727c5ac, v125
    v_rsq_f32 v125, v125
    s_nop 0
    v_mul_f32 v124, v124, v125
    v_pk_fma_f32 v[64:65], v[96:97], v[124:125], v[124:125] op_sel:[0,1,0] op_sel_hi:[1,1,0] neg_lo:[0,0,1] neg_hi:[0,0,1]
    v_pk_fma_f32 v[66:67], v[98:99], v[124:125], v[124:125] op_sel:[0,1,0] op_sel_hi:[1,1,0] neg_lo:[0,0,1] neg_hi:[0,0,1]
    v_pk_fma_f32 v[68:69], v[100:101], v[124:125], v[124:125] op_sel:[0,1,0] op_sel_hi:[1,1,0] neg_lo:[0,0,1] neg_hi:[0,0,1]
    v_pk_fma_f32 v[70:71], v[102:103], v[124:125], v[124:125] op_sel:[0,1,0] op_sel_hi:[1,1,0] neg_lo:[0,0,1] neg_hi:[0,0,1]
    v_pk_fma_f32 v[64:65], v[64:65], v[32:33], v[48:49]
    v_pk_fma_f32 v[66:67], v[66:67], v[34:35], v[50:51]
    v_pk_fma_f32 v[68:69], v[68:69], v[36:37], v[52:53]
    v_pk_fma_f32 v[70:71], v[70:71], v[38:39], v[54:55]
    v_cvt_pk_bf16_f32 v112, v64, v65
    v_cvt_pk_bf16_f32 v113, v66, v67
    v_cvt_pk_bf16_f32 v114, v68, v69
    v_cvt_pk_bf16_f32 v115, v70, v71
    s_cmp_lg_u32 s76, 0
    s_cbranch_scc1 Lsafe_144
    buffer_store_dwordx4 v[112:115], v2, s[44:47], s70 offen offset:0
Lback_145:
    v_pk_fma_f32 v[72:73], v[104:105], v[124:125], v[124:125] op_sel:[0,1,0] op_sel_hi:[1,1,0] neg_lo:[0,0,1] neg_hi:[0,0,1]
    v_pk_fma_f32 v[74:75], v[106:107], v[124:125], v[124:125] op_sel:[0,1,0] op_sel_hi:[1,1,0] neg_lo:[0,0,1] neg_hi:[0,0,1]
    v_pk_fma_f32 v[76:77], v[108:109], v[124:125], v[124:125] op_sel:[0,1,0] op_sel_hi:[1,1,0] neg_lo:[0,0,1] neg_hi:[0,0,1]
    v_pk_fma_f32 v[78:79], v[110:111], v[124:125], v[124:125] op_sel:[0,1,0] op_sel_hi:[1,1,0] neg_lo:[0,0,1] neg_hi:[0,0,1]
    v_pk_fma_f32 v[72:73], v[72:73], v[40:41], v[56:57]
    v_pk_fma_f32 v[74:75], v[74:75], v[42:43], v[58:59]
    v_pk_fma_f32 v[76:77], v[76:77], v[44:45], v[60:61]
    v_pk_fma_f32 v[78:79], v[78:79], v[46:47], v[62:63]
    v_cvt_pk_bf16_f32 v116, v72, v73
    v_cvt_pk_bf16_f32 v117, v74, v75
    v_cvt_pk_bf16_f32 v118, v76, v77
    v_cvt_pk_bf16_f32 v119, v78, v79
    s_cmp_lg_u32 s76, 0
    s_cbranch_scc1 Lsafe_146
    buffer_store_dwordx4 v[116:119], v2, s[44:47], s70 offen offset:1024
Lback_147:
    s_waitcnt vmcnt(0)
    s_cmp_lg_u32 s76, 0
    s_cbranch_scc1 Lsafe_148
    buffer_store_dword v14, v15, s[44:47], s97 offen
Lback_149:
    s_setprio 0
    v_add_u32 v21, 0x18000, v20
    ds_write_b128 v21, v[160:163] offset:0
    ds_write_b128 v21, v[164:167] offset:1024
    ds_write_b128 v21, v[168:171] offset:2048
    ds_write_b128 v21, v[172:175] offset:3072
    ds_write_b128 v21, v[176:179] offset:4096
    ds_write_b128 v21, v[180:183] offset:5120
    ds_write_b128 v21, v[184:187] offset:6144
    ds_write_b128 v21, v[188:191] offset:7168
    ds_write_b8 v5, v7 offset:576
    s_mov_b32 s68, s36
    s_mov_b32 s69, s37
    s_mov_b32 s70, 0x200000
    s_mov_b32 s71, 0x20000
    s_lshl_b32 s3, s85, 7
    v_add_u32 v29, s3, v6
    s_lshl_b32 s99, s99, 2
    s_lshl_b32 s3, s15, 1
    s_add_u32 s99, s99, s3
    v_and_b32 v21, 15, v1
    v_min_u32 v26, 10, v21
    v_lshlrev_b32 v21, 2, v21
    v_lshlrev_b32 v26, 2, v26
    s_lshl_b32 s11, s12, 7
    s_add_u32 s11, s11, 0x6000
    s_lshl_b32 s9, s12, 15
    s_lshl_b32 s3, s13, 10
    s_add_u32 s9, s9, s3
    s_add_u32 s9, s9, 0x400000
    s_mul_i32 s3, s13, 12288
    s_add_u32 s3, s3, 0x20800
    v_add_u32 v9, s3, v3
    v_add_u32 v30, s3, v4
    v_add_u32 v11, 0xffff1800, v11
    v_add_u32 v12, 0xffff1800, v12
    v_add_u32 v23, s9, v2
    s_lshl_b32 s3, s13, 15
    v_add_u32 v3, s3, v3
    v_add_u32 v4, s3, v4
    v_add_u32 v24, 0x10000, v3
    v_add_u32 v25, 0x10000, v4
    s_cmp_eq_u32 s85, 0
    s_cbranch_scc1 Ln2_150
    s_lshl_b32 s4, s74, 4
    v_add_u32 v28, s4, v6
Lev_151:
    ds_read_b32 v16, v28 offset:256
    s_waitcnt lgkmcnt(0)
    v_readfirstlane_b32 s98, v16
    s_nop 0
    s_cmp_eq_u32 s98, 0x01010101
    s_cbranch_scc1 Levd_152
    s_cmp_lg_u32 s98, 0
    s_cbranch_scc1 Levs_153
    s_sleep 3
Levs_153:
    s_sleep 1
    s_sub_u32 s77, s77, 1
    s_cbranch_scc1 L_end
    s_branch Lev_151
Levd_152:
    ds_write_b128 v20, v[192:195] offset:0
    ds_write_b128 v20, v[196:199] offset:1024
    ds_write_b128 v20, v[200:203] offset:2048
    ds_write_b128 v20, v[204:207] offset:3072
    ds_write_b128 v20, v[208:211] offset:4096
    ds_write_b128 v20, v[212:215] offset:5120
    ds_write_b128 v20, v[216:219] offset:6144
    ds_write_b128 v20, v[220:223] offset:7168
    ds_write_b128 v20, v[224:227] offset:32768
    ds_write_b128 v20, v[228:231] offset:33792
    ds_write_b128 v20, v[232:235] offset:34816
    ds_write_b128 v20, v[236:239] offset:35840
    ds_write_b128 v20, v[240:243] offset:36864
    ds_write_b128 v20, v[244:247] offset:37888
    ds_write_b128 v20, v[248:251] offset:38912
    ds_write_b128 v20, v[252:255] offset:39936
Ln2_150:
    ds_write_b8 v5, v7 offset:128
    s_lshl_b32 s8, s15, 7
    s_lshr_b32 s3, s73, 4
    s_lshl_b32 s3, s3, 2
    s_add_u32 s3, s3, s74
    s_lshl_b32 s4, s72, 3
    s_add_u32 s3, s3, s4
    s_and_b32 s4, s73, 15
    s_lshl_b32 s9, s3, 15
    s_lshl_b32 s5, s4, 11
    s_add_u32 s9, s9, s5
    s_add_u32 s9, s9, 0x400000
    s_lshl_b32 s96, s3, 7
    s_add_u32 s96, s96, 0x6000
    s_lshl_b32 s4, s4, 2
    s_add_u32 s10, s96, s4
    s_lshl_b32 s3, s74, 11
    s_add_u32 s3, s3, 0x25800
    v_add_u32 v28, s3, v2
Lev_154:
    ds_read_b32 v16, v6 offset:480
    s_waitcnt lgkmcnt(0)
    v_readfirstlane_b32 s98, v16
    s_nop 0
    s_cmp_eq_u32 s98, 0x01010101
    s_cbranch_scc1 Levd_155
    s_cmp_lg_u32 s98, 0
    s_cbranch_scc1 Levs_156
    s_sleep 3
Levs_156:
    s_sleep 1
    s_sub_u32 s77, s77, 1
    s_cbranch_scc1 L_end
    s_branch Lev_154
Levd_155:
    s_add_u32 s6, s74, 0
    s_mul_i32 s4, s6, 3
    s_lshl_b32 s5, s4, 15
    s_add_u32 s5, s5, s8
    s_add_u32 s5, s5, 0x10000
    s_lshl_b32 s6, s6, 11
    s_add_u32 m0, s6, 0x20800
    s_nop 0
    buffer_load_dwordx4 v8, s[64:67], s5 offen lds
    s_add_u32 m0, s6, 0x20bc0
    s_nop 0
    buffer_load_dwordx4 v8, s[64:67], s5 offen offset:64 lds
    s_add_u32 s5, s5, 0x4000
    s_add_u32 m0, s6, 0x23800
    s_nop 0
    buffer_load_dwordx4 v8, s[64:67], s5 offen lds
    s_add_u32 m0, s6, 0x23bc0
    s_nop 0
    buffer_load_dwordx4 v8, s[64:67], s5 offen offset:64 lds
    s_cmp_ge_u32 s74, 2
    s_cbranch_scc1 Lws_157
    s_add_u32 s6, s74, 4
    s_mul_i32 s4, s6, 3
    s_lshl_b32 s5, s4, 15
    s_add_u32 s5, s5, s8
    s_add_u32 s5, s5, 0x10000
    s_lshl_b32 s6, s6, 11
    s_add_u32 m0, s6, 0x20800
    s_nop 0
    buffer_load_dwordx4 v8, s[64:67], s5 offen lds
    s_add_u32 m0, s6, 0x20bc0
    s_nop 0
    buffer_load_dwordx4 v8, s[64:67], s5 offen offset:64 lds
    s_add_u32 s5, s5, 0x4000
    s_add_u32 m0, s6, 0x23800
    s_nop 0
    buffer_load_dwordx4 v8, s[64:67], s5 offen lds
    s_add_u32 m0, s6, 0x23bc0
    s_nop 0
    buffer_load_dwordx4 v8, s[64:67], s5 offen offset:64 lds
Lws_157:
Lev_158:
    ds_read_b32 v16, v6 offset:320
    s_waitcnt lgkmcnt(0)
    v_readfirstlane_b32 s98, v16
    s_nop 0
    s_cmp_eq_u32 s98, 0x01010101
    s_cbranch_scc1 Levd_159
    s_cmp_lg_u32 s98, 0
    s_cbranch_scc1 Levs_160
    s_sleep 3
Levs_160:
    s_sleep 1
    s_sub_u32 s77, s77, 1
    s_cbranch_scc1 L_end
    s_branch Lev_158
Levd_159:
    s_add_u32 s6, s74, 0
    s_add_u32 s3, s6, s99
    s_and_b32 s3, s3, 15
    s_mul_i32 s4, s3, 3
    s_lshl_b32 s5, s3, 1
    s_add_u32 s5, s5, 11
    s_min_u32 s4, s4, s5
    s_lshl_b32 s5, s4, 15
    s_add_u32 s5, s5, s8
    s_lshl_b32 s6, s6, 11
    s_add_u32 m0, s6, 0x10000
    s_waitcnt vmcnt(7)
    buffer_load_dwordx4 v8, s[64:67], s5 offen lds
    s_add_u32 m0, s6, 0x103c0
    s_waitcnt vmcnt(7)
    buffer_load_dwordx4 v8, s[64:67], s5 offen offset:64 lds
    s_add_u32 s5, s5, 0x4000
    s_add_u32 m0, s6, 0x18000
    s_waitcnt vmcnt(7)
    buffer_load_dwordx4 v8, s[64:67], s5 offen lds
    s_add_u32 m0, s6, 0x183c0
    s_waitcnt vmcnt(7)
    buffer_load_dwordx4 v8, s[64:67], s5 offen offset:64 lds
Lev_161:
    ds_read_b32 v16, v6 offset:336
    s_waitcnt lgkmcnt(0)
    v_readfirstlane_b32 s98, v16
    s_nop 0
    s_cmp_eq_u32 s98, 0x01010101
    s_cbranch_scc1 Levd_162
    s_cmp_lg_u32 s98, 0
    s_cbranch_scc1 Levs_163
    s_sleep 3
Levs_163:
    s_sleep 1
    s_sub_u32 s77, s77, 1
    s_cbranch_scc1 L_end
    s_branch Lev_161
Levd_162:
    s_add_u32 s6, s74, 4
    s_add_u32 s3, s6, s99
    s_and_b32 s3, s3, 15
    s_mul_i32 s4, s3, 3
    s_lshl_b32 s5, s3, 1
    s_add_u32 s5, s5, 11
    s_min_u32 s4, s4, s5
    s_lshl_b32 s5, s4, 15
    s_add_u32 s5, s5, s8
    s_lshl_b32 s6, s6, 11
    s_add_u32 m0, s6, 0x10000
    s_waitcnt vmcnt(7)
    buffer_load_dwordx4 v8, s[64:67], s5 offen lds
    s_add_u32 m0, s6, 0x103c0
    s_waitcnt vmcnt(7)
    buffer_load_dwordx4 v8, s[64:67], s5 offen offset:64 lds
    s_add_u32 s5, s5, 0x4000
    s_add_u32 m0, s6, 0x18000
    s_waitcnt vmcnt(7)
    buffer_load_dwordx4 v8, s[64:67], s5 offen lds
    s_add_u32 m0, s6, 0x183c0
    s_waitcnt vmcnt(7)
    buffer_load_dwordx4 v8, s[64:67], s5 offen offset:64 lds
    buffer_load_dword v22, v21, s[44:47], s11 offen sc1
    s_waitcnt vmcnt(0)
    v_cmp_ne_u32 vcc, s75, v22
    s_cbranch_vccnz Lpoll_164
Lpollb_165:
    s_lshl_b32 s7, s99, 11
    s_and_b32 s7, s7, 0x7fff
    buffer_load_dwordx4 v[128:131], v23, s[44:47], s7 offen offset:0 sc1
    buffer_load_dwordx4 v[132:135], v23, s[44:47], s7 offen offset:2048 sc1
    s_add_u32 s7, s7, 4096
    s_and_b32 s7, s7, 0x7fff
    buffer_load_dwordx4 v[136:139], v23, s[44:47], s7 offen offset:0 sc1
    buffer_load_dwordx4 v[140:143], v23, s[44:47], s7 offen offset:2048 sc1
    s_add_u32 s7, s7, 4096
    s_and_b32 s7, s7, 0x7fff
    buffer_load_dwordx4 v[144:147], v23, s[44:47], s7 offen offset:0 sc1
    buffer_load_dwordx4 v[148:151], v23, s[44:47], s7 offen offset:2048 sc1
    s_add_u32 s7, s7, 4096
    s_and_b32 s7, s7, 0x7fff
    buffer_load_dwordx4 v[152:155], v23, s[44:47], s7 offen offset:0 sc1
    buffer_load_dwordx4 v[156:159], v23, s[44:47], s7 offen offset:2048 sc1
    s_add_u32 s7, s7, 4096
    s_and_b32 s7, s7, 0x7fff
    s_waitcnt vmcnt(7)
    buffer_load_dwordx4 v[160:163], v23, s[44:47], s7 offen offset:0 sc1
    s_waitcnt vmcnt(7)
    buffer_load_dwordx4 v[164:167], v23, s[44:47], s7 offen offset:2048 sc1
    s_add_u32 s7, s7, 4096
    s_and_b32 s7, s7, 0x7fff
    s_waitcnt vmcnt(7)
    buffer_load_dwordx4 v[168:171], v23, s[44:47], s7 offen offset:0 sc1
    s_waitcnt vmcnt(7)
    buffer_load_dwordx4 v[172:175], v23, s[44:47], s7 offen offset:2048 sc1
    s_add_u32 s7, s7, 4096
    s_and_b32 s7, s7, 0x7fff
    s_waitcnt vmcnt(7)
    buffer_load_dwordx4 v[176:179], v23, s[44:47], s7 offen offset:0 sc1
    s_waitcnt vmcnt(7)
    buffer_load_dwordx4 v[180:183], v23, s[44:47], s7 offen offset:2048 sc1
    s_add_u32 s7, s7, 4096
    s_and_b32 s7, s7, 0x7fff
    s_waitcnt vmcnt(7)
    buffer_load_dwordx4 v[184:187], v23, s[44:47], s7 offen offset:0 sc1
    s_waitcnt vmcnt(7)
    buffer_load_dwordx4 v[188:191], v23, s[44:47], s7 offen offset:2048 sc1
    v_add_u32 v23, 0xffe00000, v23
    s_add_u32 s11, s11, 0x2000
Lev_166:
    ds_read_b32 v16, v6 offset:352
    s_waitcnt lgkmcnt(0)
    v_readfirstlane_b32 s98, v16
    s_nop 0
    s_cmp_eq_u32 s98, 0x01010101
    s_cbranch_scc1 Levd_167
    s_cmp_lg_u32 s98, 0
    s_cbranch_scc1 Levs_168
    s_sleep 3
Levs_168:
    s_sleep 1
    s_sub_u32 s77, s77, 1
    s_cbranch_scc1 L_end
    s_branch Lev_166
Levd_167:
    s_add_u32 s6, s74, 8
    s_add_u32 s3, s6, s99
    s_and_b32 s3, s3, 15
    s_mul_i32 s4, s3, 3
    s_lshl_b32 s5, s3, 1
    s_add_u32 s5, s5, 11
    s_min_u32 s4, s4, s5
    s_lshl_b32 s5, s4, 15
    s_add_u32 s5, s5, s8
    s_lshl_b32 s6, s6, 11
    s_add_u32 m0, s6, 0x10000
    s_waitcnt vmcnt(7)
    buffer_load_dwordx4 v8, s[64:67], s5 offen lds
    s_add_u32 m0, s6, 0x103c0
    s_waitcnt vmcnt(7)
    buffer_load_dwordx4 v8, s[64:67], s5 offen offset:64 lds
    s_add_u32 s5, s5, 0x4000
    s_add_u32 m0, s6, 0x18000
    s_waitcnt vmcnt(7)
    buffer_load_dwordx4 v8, s[64:67], s5 offen lds
    s_add_u32 m0, s6, 0x183c0
    s_waitcnt vmcnt(7)
    buffer_load_dwordx4 v8, s[64:67], s5 offen offset:64 lds
Lev_169:
    ds_read_b32 v16, v6 offset:368
    s_waitcnt lgkmcnt(0)
    v_readfirstlane_b32 s98, v16
    s_nop 0
    s_cmp_eq_u32 s98, 0x01010101
    s_cbranch_scc1 Levd_170
    s_cmp_lg_u32 s98, 0
    s_cbranch_scc1 Levs_171
    s_sleep 3
Levs_171:
    s_sleep 1
    s_sub_u32 s77, s77, 1
    s_cbranch_scc1 L_end
    s_branch Lev_169
Levd_170:
    s_add_u32 s6, s74, 12
    s_add_u32 s3, s6, s99
    s_and_b32 s3, s3, 15
    s_mul_i32 s4, s3, 3
    s_lshl_b32 s5, s3, 1
    s_add_u32 s5, s5, 11
    s_min_u32 s4, s4, s5
    s_lshl_b32 s5, s4, 15
    s_add_u32 s5, s5, s8
    s_lshl_b32 s6, s6, 11
    s_add_u32 m0, s6, 0x10000
    s_waitcnt vmcnt(7)
    buffer_load_dwordx4 v8, s[64:67], s5 offen lds
    s_add_u32 m0, s6, 0x103c0
    s_waitcnt vmcnt(7)
    buffer_load_dwordx4 v8, s[64:67], s5 offen offset:64 lds
    s_add_u32 s5, s5, 0x4000
    s_add_u32 m0, s6, 0x18000
    s_waitcnt vmcnt(7)
    buffer_load_dwordx4 v8, s[64:67], s5 offen lds
    s_add_u32 m0, s6, 0x183c0
    s_waitcnt vmcnt(7)
    buffer_load_dwordx4 v8, s[64:67], s5 offen offset:64 lds
Lev_172:
    ds_read_b32 v16, v29 offset:256
    s_waitcnt lgkmcnt(0)
    v_readfirstlane_b32 s98, v16
    s_nop 0
    s_cmp_eq_u32 s98, 0x01010101
    s_cbranch_scc1 Levd_173
    s_cmp_lg_u32 s98, 0
    s_cbranch_scc1 Levs_174
    s_sleep 3
Levs_174:
    s_sleep 1
    s_sub_u32 s77, s77, 1
    s_cbranch_scc1 L_end
    s_branch Lev_172
Levd_173:
    s_add_u32 s6, s74, 0
    s_add_u32 s3, s6, s99
    s_and_b32 s3, s3, 15
    s_mul_i32 s4, s3, 3
    s_lshl_b32 s5, s3, 1
    s_add_u32 s5, s5, 11
    s_min_u32 s4, s4, s5
    s_lshl_b32 s5, s4, 15
    s_add_u32 s5, s5, s8
    s_add_u32 s5, s5, 0x8000
    s_lshl_b32 s6, s6, 11
    s_add_u32 m0, s6, 0x0
    s_waitcnt vmcnt(7)
    buffer_load_dwordx4 v8, s[64:67], s5 offen lds
    s_add_u32 m0, s6, 0x3c0
    s_waitcnt vmcnt(7)
    buffer_load_dwordx4 v8, s[64:67], s5 offen offset:64 lds
    s_add_u32 s5, s5, 0x4000
    s_add_u32 m0, s6, 0x8000
    s_waitcnt vmcnt(7)
    buffer_load_dwordx4 v8, s[64:67], s5 offen lds
    s_add_u32 m0, s6, 0x83c0
    s_waitcnt vmcnt(7)
    buffer_load_dwordx4 v8, s[64:67], s5 offen offset:64 lds
Lev_175:
    ds_read_b32 v16, v29 offset:272
    s_waitcnt lgkmcnt(0)
    v_readfirstlane_b32 s98, v16
    s_nop 0
    s_cmp_eq_u32 s98, 0x01010101
    s_cbranch_scc1 Levd_176
    s_cmp_lg_u32 s98, 0
    s_cbranch_scc1 Levs_177
    s_sleep 3
Levs_177:
    s_sleep 1
    s_sub_u32 s77, s77, 1
    s_cbranch_scc1 L_end
    s_branch Lev_175
Levd_176:
    s_add_u32 s6, s74, 4
    s_add_u32 s3, s6, s99
    s_and_b32 s3, s3, 15
    s_mul_i32 s4, s3, 3
    s_lshl_b32 s5, s3, 1
    s_add_u32 s5, s5, 11
    s_min_u32 s4, s4, s5
    s_lshl_b32 s5, s4, 15
    s_add_u32 s5, s5, s8
    s_add_u32 s5, s5, 0x8000
    s_lshl_b32 s6, s6, 11
    s_add_u32 m0, s6, 0x0
    s_waitcnt vmcnt(7)
    buffer_load_dwordx4 v8, s[64:67], s5 offen lds
    s_add_u32 m0, s6, 0x3c0
    s_waitcnt vmcnt(7)
    buffer_load_dwordx4 v8, s[64:67], s5 offen offset:64 lds
    s_add_u32 s5, s5, 0x4000
    s_add_u32 m0, s6, 0x8000
    s_waitcnt vmcnt(7)
    buffer_load_dwordx4 v8, s[64:67], s5 offen lds
    s_add_u32 m0, s6, 0x83c0
    s_waitcnt vmcnt(7)
    ds_write_b8 v5, v7 offset:144
    buffer_load_dwordx4 v8, s[64:67], s5 offen offset:64 lds
Lev_178:
    ds_read_b32 v16, v29 offset:288
    s_waitcnt lgkmcnt(0)
    v_readfirstlane_b32 s98, v16
    s_nop 0
    s_cmp_eq_u32 s98, 0x01010101
    s_cbranch_scc1 Levd_179
    s_cmp_lg_u32 s98, 0
    s_cbranch_scc1 Levs_180
    s_sleep 3
Levs_180:
    s_sleep 1
    s_sub_u32 s77, s77, 1
    s_cbranch_scc1 L_end
    s_branch Lev_178
Levd_179:
    s_add_u32 s6, s74, 8
    s_add_u32 s3, s6, s99
    s_and_b32 s3, s3, 15
    s_mul_i32 s4, s3, 3
    s_lshl_b32 s5, s3, 1
    s_add_u32 s5, s5, 11
    s_min_u32 s4, s4, s5
    s_lshl_b32 s5, s4, 15
    s_add_u32 s5, s5, s8
    s_add_u32 s5, s5, 0x8000
    s_lshl_b32 s6, s6, 11
    s_add_u32 m0, s6, 0x0
    s_waitcnt vmcnt(7)
    buffer_load_dwordx4 v8, s[64:67], s5 offen lds
    s_add_u32 m0, s6, 0x3c0
    s_waitcnt vmcnt(7)
    buffer_load_dwordx4 v8, s[64:67], s5 offen offset:64 lds
    s_add_u32 s5, s5, 0x4000
    s_add_u32 m0, s6, 0x8000
    s_waitcnt vmcnt(7)
    buffer_load_dwordx4 v8, s[64:67], s5 offen lds
    s_add_u32 m0, s6, 0x83c0
    s_waitcnt vmcnt(7)
    buffer_load_dwordx4 v8, s[64:67], s5 offen offset:64 lds
Lev_181:
    ds_read_b32 v16, v29 offset:304
    s_waitcnt lgkmcnt(0)
    v_readfirstlane_b32 s98, v16
    s_nop 0
    s_cmp_eq_u32 s98, 0x01010101
    s_cbranch_scc1 Levd_182
    s_cmp_lg_u32 s98, 0
    s_cbranch_scc1 Levs_183
    s_sleep 3
Levs_183:
    s_sleep 1
    s_sub_u32 s77, s77, 1
    s_cbranch_scc1 L_end
    s_branch Lev_181
Levd_182:
    buffer_load_dword v22, v21, s[44:47], s11 offen sc1
    s_add_u32 s6, s74, 12
    s_add_u32 s3, s6, s99
    s_and_b32 s3, s3, 15
    s_mul_i32 s4, s3, 3
    s_lshl_b32 s5, s3, 1
    s_add_u32 s5, s5, 11
    s_min_u32 s4, s4, s5
    s_lshl_b32 s5, s4, 15
    s_add_u32 s5, s5, s8
    s_add_u32 s5, s5, 0x8000
    s_lshl_b32 s6, s6, 11
    s_add_u32 m0, s6, 0x0
    s_waitcnt vmcnt(7)
    buffer_load_dwordx4 v8, s[64:67], s5 offen lds
    s_add_u32 m0, s6, 0x3c0
    s_waitcnt vmcnt(7)
    buffer_load_dwordx4 v8, s[64:67], s5 offen offset:64 lds
    s_add_u32 s5, s5, 0x4000
    s_add_u32 m0, s6, 0x8000
    s_waitcnt vmcnt(7)
    buffer_load_dwordx4 v8, s[64:67], s5 offen lds
    s_add_u32 m0, s6, 0x83c0
    s_waitcnt vmcnt(7)
    buffer_load_dwordx4 v8, s[64:67], s5 offen offset:64 lds
Lev_184:
    ds_read_b32 v16, v6 offset:144
    s_waitcnt lgkmcnt(0)
    v_readfirstlane_b32 s98, v16
    s_nop 0
    s_cmp_eq_u32 s98, 0x01010101
    s_cbranch_scc1 Levd_185
    s_cmp_lg_u32 s98, 0
    s_cbranch_scc1 Levs_186
    s_sleep 3
Levs_186:
    s_sleep 1
    s_sub_u32 s77, s77, 1
    s_cbranch_scc1 L_end
    s_branch Lev_184
Levd_185:
    ds_read_b64_tr_b16 v[32:33], v25 offset:0
    ds_read_b64_tr_b16 v[34:35], v25 offset:512
    ds_read_b64_tr_b16 v[36:37], v24 offset:0
    ds_read_b64_tr_b16 v[38:39], v24 offset:512
    ds_read_b64_tr_b16 v[40:41], v25 offset:2048
    ds_read_b64_tr_b16 v[42:43], v25 offset:2560
    ds_read_b64_tr_b16 v[44:45], v24 offset:2048
    ds_read_b64_tr_b16 v[46:47], v24 offset:2560
    ds_read_b64_tr_b16 v[48:49], v25 offset:4096
    ds_read_b64_tr_b16 v[50:51], v25 offset:4608
    ds_read_b64_tr_b16 v[52:53], v24 offset:4096
    ds_read_b64_tr_b16 v[54:55], v24 offset:4608
    s_waitcnt lgkmcnt(10)
    v_mfma_f32_32x32x16_bf16 v[80:95], v[32:35], v[128:131], 0
    ds_read_b64_tr_b16 v[56:57], v25 offset:6144
    ds_read_b64_tr_b16 v[58:59], v25 offset:6656
    s_waitcnt lgkmcnt(10)
    v_mfma_f32_32x32x16_bf16 v[64:79], v[36:39], v[128:131], 0
    ds_read_b64_tr_b16 v[60:61], v24 offset:6144
    ds_read_b64_tr_b16 v[62:63], v24 offset:6656
    ds_write_b8 v5, v7 offset:608
    s_waitcnt lgkmcnt(11)
    v_mfma_f32_32x32x16_bf16 v[80:95], v[40:43], v[132:135], v[80:95]
    ds_read_b64_tr_b16 v[32:33], v25 offset:8192
    ds_read_b64_tr_b16 v[34:35], v25 offset:8704
    s_waitcnt lgkmcnt(11)
    v_mfma_f32_32x32x16_bf16 v[64:79], v[44:47], v[132:135], v[64:79]
    ds_read_b64_tr_b16 v[36:37], v24 offset:8192
    ds_read_b64_tr_b16 v[38:39], v24 offset:8704
    s_waitcnt lgkmcnt(11)
    v_mfma_f32_32x32x16_bf16 v[80:95], v[48:51], v[136:139], v[80:95]
    ds_read_b64_tr_b16 v[40:41], v25 offset:10240
    ds_read_b64_tr_b16 v[42:43], v25 offset:10752
    s_waitcnt vmcnt(4)
    v_cmp_ne_u32 vcc, s75, v22
    s_cbranch_vccnz Lpoll_187
Lpollb_188:
    s_waitcnt lgkmcnt(11)
    v_mfma_f32_32x32x16_bf16 v[64:79], v[52:55], v[136:139], v[64:79]
    ds_read_b64_tr_b16 v[44:45], v24 offset:10240
    ds_read_b64_tr_b16 v[46:47], v24 offset:10752
    s_lshl_b32 s7, s99, 11
    s_and_b32 s7, s7, 0x7fff
    buffer_load_dwordx4 v[192:195], v23, s[44:47], s7 offen offset:0 sc1
    buffer_load_dwordx4 v[196:199], v23, s[44:47], s7 offen offset:2048 sc1
    s_add_u32 s7, s7, 4096
    s_and_b32 s7, s7, 0x7fff
    buffer_load_dwordx4 v[200:203], v23, s[44:47], s7 offen offset:0 sc1
    buffer_load_dwordx4 v[204:207], v23, s[44:47], s7 offen offset:2048 sc1
    s_add_u32 s7, s7, 4096
    s_and_b32 s7, s7, 0x7fff
    buffer_load_dwordx4 v[208:211], v23, s[44:47], s7 offen offset:0 sc1
    buffer_load_dwordx4 v[212:215], v23, s[44:47], s7 offen offset:2048 sc1
    s_waitcnt lgkmcnt(11)
    v_mfma_f32_32x32x16_bf16 v[80:95], v[56:59], v[140:143], v[80:95]
    ds_read_b64_tr_b16 v[48:49], v25 offset:12288
    ds_read_b64_tr_b16 v[50:51], v25 offset:12800
    s_waitcnt lgkmcnt(11)
    v_mfma_f32_32x32x16_bf16 v[64:79], v[60:63], v[140:143], v[64:79]
    ds_read_b64_tr_b16 v[52:53], v24 offset:12288
    ds_read_b64_tr_b16 v[54:55], v24 offset:12800
    s_add_u32 s7, s7, 4096
    s_and_b32 s7, s7, 0x7fff
    buffer_load_dwordx4 v[216:219], v23, s[44:47], s7 offen offset:0 sc1
    s_waitcnt lgkmcnt(10)
    v_mfma_f32_32x32x16_bf16 v[80:95], v[32:35], v[144:147], v[80:95]
    ds_read_b64_tr_b16 v[56:57], v25 offset:14336
    ds_read_b64_tr_b16 v[58:59], v25 offset:14848
    s_waitcnt lgkmcnt(10)
    v_mfma_f32_32x32x16_bf16 v[64:79], v[36:39], v[144:147], v[64:79]
    ds_read_b64_tr_b16 v[60:61], v24 offset:14336
    ds_read_b64_tr_b16 v[62:63], v24 offset:14848
    ds_write_b8 v5, v7 offset:624
    buffer_load_dwordx4 v[220:223], v23, s[44:47], s7 offen offset:2048 sc1
    s_waitcnt lgkmcnt(11)
    v_mfma_f32_32x32x16_bf16 v[80:95], v[40:43], v[148:151], v[80:95]
    ds_read_b64_tr_b16 v[32:33], v25 offset:16384
    ds_read_b64_tr_b16 v[34:35], v25 offset:16896
    s_waitcnt lgkmcnt(11)
    v_mfma_f32_32x32x16_bf16 v[64:79], v[44:47], v[148:151], v[64:79]
    ds_read_b64_tr_b16 v[36:37], v24 offset:16384
    ds_read_b64_tr_b16 v[38:39], v24 offset:16896
    s_add_u32 s7, s7, 4096
    s_and_b32 s7, s7, 0x7fff
    buffer_load_dwordx4 v[224:227], v23, s[44:47], s7 offen offset:0 sc1
    s_waitcnt lgkmcnt(11)
    v_mfma_f32_32x32x16_bf16 v[80:95], v[48:51], v[152:155], v[80:95]
    ds_read_b64_tr_b16 v[40:41], v25 offset:18432
    ds_read_b64_tr_b16 v[42:43], v25 offset:18944
    s_waitcnt lgkmcnt(11)
    v_mfma_f32_32x32x16_bf16 v[64:79], v[52:55], v[152:155], v[64:79]
    ds_read_b64_tr_b16 v[44:45], v24 offset:18432
    ds_read_b64_tr_b16 v[46:47], v24 offset:18944
    buffer_load_dwordx4 v[228:231], v23, s[44:47], s7 offen offset:2048 sc1
    s_waitcnt lgkmcnt(11)
    v_mfma_f32_32x32x16_bf16 v[80:95], v[56:59], v[156:159], v[80:95]
    ds_read_b64_tr_b16 v[48:49], v25 offset:20480
    ds_read_b64_tr_b16 v[50:51], v25 offset:20992
    s_waitcnt lgkmcnt(11)
    v_mfma_f32_32x32x16_bf16 v[64:79], v[60:63], v[156:159], v[64:79]
    ds_read_b64_tr_b16 v[52:53], v24 offset:20480
    ds_read_b64_tr_b16 v[54:55], v24 offset:20992
    s_add_u32 s7, s7, 4096
    s_and_b32 s7, s7, 0x7fff
    buffer_load_dwordx4 v[232:235], v23, s[44:47], s7 offen offset:0 sc1
    s_waitcnt lgkmcnt(10)
    v_mfma_f32_32x32x16_bf16 v[80:95], v[32:35], v[160:163], v[80:95]
    ds_read_b64_tr_b16 v[56:57], v25 offset:22528
    ds_read_b64_tr_b16 v[58:59], v25 offset:23040
    s_waitcnt vmcnt(11)
    ds_write_b8 v5, v7 offset:160
    s_waitcnt lgkmcnt(11)
    v_mfma_f32_32x32x16_bf16 v[64:79], v[36:39], v[160:163], v[64:79]
    ds_read_b64_tr_b16 v[60:61], v24 offset:22528
    ds_read_b64_tr_b16 v[62:63], v24 offset:23040
    buffer_load_dwordx4 v[236:239], v23, s[44:47], s7 offen offset:2048 sc1
    s_waitcnt lgkmcnt(11)
    v_mfma_f32_32x32x16_bf16 v[80:95], v[40:43], v[164:167], v[80:95]
    ds_read_b64_tr_b16 v[32:33], v25 offset:24576
    ds_read_b64_tr_b16 v[34:35], v25 offset:25088
    s_waitcnt lgkmcnt(11)
    v_mfma_f32_32x32x16_bf16 v[64:79], v[44:47], v[164:167], v[64:79]
    ds_read_b64_tr_b16 v[36:37], v24 offset:24576
    ds_read_b64_tr_b16 v[38:39], v24 offset:25088
    s_add_u32 s7, s7, 4096
    s_and_b32 s7, s7, 0x7fff
    buffer_load_dwordx4 v[240:243], v23, s[44:47], s7 offen offset:0 sc1
    s_waitcnt lgkmcnt(11)
    v_mfma_f32_32x32x16_bf16 v[80:95], v[48:51], v[168:171], v[80:95]
    ds_read_b64_tr_b16 v[40:41], v25 offset:26624
    ds_read_b64_tr_b16 v[42:43], v25 offset:27136
    s_waitcnt lgkmcnt(11)
    v_mfma_f32_32x32x16_bf16 v[64:79], v[52:55], v[168:171], v[64:79]
    ds_read_b64_tr_b16 v[44:45], v24 offset:26624
    ds_read_b64_tr_b16 v[46:47], v24 offset:27136
    buffer_load_dwordx4 v[244:247], v23, s[44:47], s7 offen offset:2048 sc1
    ds_read_b32 v16, v6 offset:160
    s_waitcnt lgkmcnt(12)
    v_mfma_f32_32x32x16_bf16 v[80:95], v[56:59], v[172:175], v[80:95]
    ds_read_b64_tr_b16 v[48:49], v25 offset:28672
    ds_read_b64_tr_b16 v[50:51], v25 offset:29184
    s_waitcnt lgkmcnt(11)
    v_mfma_f32_32x32x16_bf16 v[64:79], v[60:63], v[172:175], v[64:79]
    ds_read_b64_tr_b16 v[52:53], v24 offset:28672
    ds_read_b64_tr_b16 v[54:55], v24 offset:29184
    s_add_u32 s7, s7, 4096
    s_and_b32 s7, s7, 0x7fff
    buffer_load_dwordx4 v[248:251], v23, s[44:47], s7 offen offset:0 sc1
    s_waitcnt lgkmcnt(11)
    v_mfma_f32_32x32x16_bf16 v[80:95], v[32:35], v[176:179], v[80:95]
    ds_read_b64_tr_b16 v[56:57], v25 offset:30720
    ds_read_b64_tr_b16 v[58:59], v25 offset:31232
    s_waitcnt lgkmcnt(11)
    v_mfma_f32_32x32x16_bf16 v[64:79], v[36:39], v[176:179], v[64:79]
    ds_read_b64_tr_b16 v[60:61], v24 offset:30720
    ds_read_b64_tr_b16 v[62:63], v24 offset:31232
    ds_write_b8 v5, v7 offset:656
    buffer_load_dwordx4 v[252:255], v23, s[44:47], s7 offen offset:2048 sc1
    v_add_u32 v23, 0x400000, v23
    s_add_u32 s11, s11, 0x2000
    s_waitcnt lgkmcnt(12)
    v_mfma_f32_32x32x16_bf16 v[80:95], v[40:43], v[180:183], v[80:95]
    s_waitcnt lgkmcnt(9)
    v_cmp_ne_u32 vcc, 0x01010101, v16
    s_cbranch_vccnz Lspin_189
Lspinb_190:
    ds_read_b64_tr_b16 v[32:33], v4 offset:0
    ds_read_b64_tr_b16 v[34:35], v4 offset:512
    v_mfma_f32_32x32x16_bf16 v[64:79], v[44:47], v[180:183], v[64:79]
    ds_read_b64_tr_b16 v[36:37], v3 offset:0
    ds_read_b64_tr_b16 v[38:39], v3 offset:512
    s_waitcnt lgkmcnt(11)
    v_mfma_f32_32x32x16_bf16 v[80:95], v[48:51], v[184:187], v[80:95]
    ds_read_b64_tr_b16 v[40:41], v4 offset:2048
    ds_read_b64_tr_b16 v[42:43], v4 offset:2560
    buffer_load_dword v22, v26, s[44:47], s11 offen sc1
    s_waitcnt lgkmcnt(11)
    v_mfma_f32_32x32x16_bf16 v[64:79], v[52:55], v[184:187], v[64:79]
    ds_read_b64_tr_b16 v[44:45], v3 offset:2048
    ds_read_b64_tr_b16 v[46:47], v3 offset:2560
    s_waitcnt lgkmcnt(11)
    v_mfma_f32_32x32x16_bf16 v[80:95], v[56:59], v[188:191], v[80:95]
    ds_read_b64_tr_b16 v[48:49], v4 offset:4096
    ds_read_b64_tr_b16 v[50:51], v4 offset:4608
    s_waitcnt lgkmcnt(11)
    v_mfma_f32_32x32x16_bf16 v[64:79], v[60:63], v[188:191], v[64:79]
    ds_read_b64_tr_b16 v[52:53], v3 offset:4096
    ds_read_b64_tr_b16 v[54:55], v3 offset:4608
    s_waitcnt vmcnt(16)
    s_waitcnt lgkmcnt(10)
    v_mfma_f32_32x32x16_bf16 v[80:95], v[32:35], v[192:195], v[80:95]
    ds_read_b64_tr_b16 v[56:57], v4 offset:6144
    ds_read_b64_tr_b16 v[58:59], v4 offset:6656
    s_waitcnt lgkmcnt(10)
    v_mfma_f32_32x32x16_bf16 v[64:79], v[36:39], v[192:195], v[64:79]
    ds_read_b64_tr_b16 v[60:61], v3 offset:6144
    ds_read_b64_tr_b16 v[62:63], v3 offset:6656
    s_waitcnt vmcnt(15)
    s_waitcnt lgkmcnt(10)
    v_mfma_f32_32x32x16_bf16 v[80:95], v[40:43], v[196:199], v[80:95]
    ds_read_b64_tr_b16 v[32:33], v4 offset:8192
    ds_read_b64_tr_b16 v[34:35], v4 offset:8704
    s_waitcnt lgkmcnt(10)
    v_mfma_f32_32x32x16_bf16 v[64:79], v[44:47], v[196:199], v[64:79]
    ds_read_b64_tr_b16 v[36:37], v3 offset:8192
    ds_read_b64_tr_b16 v[38:39], v3 offset:8704
    s_waitcnt vmcnt(14)
    s_waitcnt lgkmcnt(10)
    v_mfma_f32_32x32x16_bf16 v[80:95], v[48:51], v[200:203], v[80:95]
    ds_read_b64_tr_b16 v[40:41], v4 offset:10240
    ds_read_b64_tr_b16 v[42:43], v4 offset:10752
    s_waitcnt vmcnt(0)
    v_cmp_ne_u32 vcc, s75, v22
    s_cbranch_vccnz Lpoll_191
Lpollb_192:
    s_waitcnt lgkmcnt(10)
    v_mfma_f32_32x32x16_bf16 v[64:79], v[52:55], v[200:203], v[64:79]
    ds_read_b64_tr_b16 v[44:45], v3 offset:10240
    ds_read_b64_tr_b16 v[46:47], v3 offset:10752
    s_mov_b32 s7, 0
    buffer_load_dwordx4 v[128:131], v23, s[44:47], s7 offen offset:0 sc1
    s_waitcnt lgkmcnt(10)
    v_mfma_f32_32x32x16_bf16 v[80:95], v[56:59], v[204:207], v[80:95]
    ds_read_b64_tr_b16 v[48:49], v4 offset:12288
    ds_read_b64_tr_b16 v[50:51], v4 offset:12800
    buffer_load_dwordx4 v[132:135], v23, s[44:47], s7 offen offset:2048 sc1
    s_waitcnt lgkmcnt(10)
    v_mfma_f32_32x32x16_bf16 v[64:79], v[60:63], v[204:207], v[64:79]
    ds_read_b64_tr_b16 v[52:53], v3 offset:12288
    ds_read_b64_tr_b16 v[54:55], v3 offset:12800
    s_add_u32 s7, s7, 4096
    buffer_load_dwordx4 v[136:139], v23, s[44:47], s7 offen offset:0 sc1
    s_waitcnt lgkmcnt(10)
    v_mfma_f32_32x32x16_bf16 v[80:95], v[32:35], v[208:211], v[80:95]
    ds_read_b64_tr_b16 v[56:57], v4 offset:14336
    ds_read_b64_tr_b16 v[58:59], v4 offset:14848
    buffer_load_dwordx4 v[140:143], v23, s[44:47], s7 offen offset:2048 sc1
    s_waitcnt lgkmcnt(10)
    v_mfma_f32_32x32x16_bf16 v[64:79], v[36:39], v[208:211], v[64:79]
    ds_read_b64_tr_b16 v[60:61], v3 offset:14336
    ds_read_b64_tr_b16 v[62:63], v3 offset:14848
    s_add_u32 s7, s7, 4096
    buffer_load_dwordx4 v[144:147], v23, s[44:47], s7 offen offset:0 sc1
    s_waitcnt lgkmcnt(10)
    v_mfma_f32_32x32x16_bf16 v[80:95], v[40:43], v[212:215], v[80:95]
    ds_read_b64_tr_b16 v[32:33], v4 offset:16384
    ds_read_b64_tr_b16 v[34:35], v4 offset:16896
    buffer_load_dwordx4 v[148:151], v23, s[44:47], s7 offen offset:2048 sc1
    s_waitcnt lgkmcnt(10)
    v_mfma_f32_32x32x16_bf16 v[64:79], v[44:47], v[212:215], v[64:79]
    ds_read_b64_tr_b16 v[36:37], v3 offset:16384
    ds_read_b64_tr_b16 v[38:39], v3 offset:16896
    s_add_u32 s7, s7, 4096
    buffer_load_dwordx4 v[152:155], v23, s[44:47], s7 offen offset:0 sc1
    s_waitcnt lgkmcnt(10)
    v_mfma_f32_32x32x16_bf16 v[80:95], v[48:51], v[216:219], v[80:95]
    ds_read_b64_tr_b16 v[40:41], v4 offset:18432
    ds_read_b64_tr_b16 v[42:43], v4 offset:18944
    buffer_load_dwordx4 v[156:159], v23, s[44:47], s7 offen offset:2048 sc1
    s_waitcnt lgkmcnt(10)
    v_mfma_f32_32x32x16_bf16 v[64:79], v[52:55], v[216:219], v[64:79]
    ds_read_b64_tr_b16 v[44:45], v3 offset:18432
    ds_read_b64_tr_b16 v[46:47], v3 offset:18944
    s_add_u32 s7, s7, 4096
    buffer_load_dwordx4 v[160:163], v23, s[44:47], s7 offen offset:0 sc1
    s_waitcnt lgkmcnt(10)
    v_mfma_f32_32x32x16_bf16 v[80:95], v[56:59], v[220:223], v[80:95]
    ds_read_b64_tr_b16 v[48:49], v4 offset:20480
    ds_read_b64_tr_b16 v[50:51], v4 offset:20992
    buffer_load_dwordx4 v[164:167], v23, s[44:47], s7 offen offset:2048 sc1
    s_waitcnt lgkmcnt(10)
    v_mfma_f32_32x32x16_bf16 v[64:79], v[60:63], v[220:223], v[64:79]
    ds_read_b64_tr_b16 v[52:53], v3 offset:20480
    ds_read_b64_tr_b16 v[54:55], v3 offset:20992
    s_add_u32 s7, s7, 4096
    buffer_load_dwordx4 v[168:171], v23, s[44:47], s7 offen offset:0 sc1
    s_waitcnt lgkmcnt(10)
    v_mfma_f32_32x32x16_bf16 v[80:95], v[32:35], v[224:227], v[80:95]
    ds_read_b64_tr_b16 v[56:57], v4 offset:22528
    ds_read_b64_tr_b16 v[58:59], v4 offset:23040
    s_waitcnt lgkmcnt(10)
    v_mfma_f32_32x32x16_bf16 v[64:79], v[36:39], v[224:227], v[64:79]
    ds_read_b64_tr_b16 v[60:61], v3 offset:22528
    ds_read_b64_tr_b16 v[62:63], v3 offset:23040
    s_waitcnt lgkmcnt(10)
    v_mfma_f32_32x32x16_bf16 v[80:95], v[40:43], v[228:231], v[80:95]
    ds_read_b64_tr_b16 v[32:33], v4 offset:24576
    ds_read_b64_tr_b16 v[34:35], v4 offset:25088
    s_waitcnt lgkmcnt(10)
    v_mfma_f32_32x32x16_bf16 v[64:79], v[44:47], v[228:231], v[64:79]
    ds_read_b64_tr_b16 v[36:37], v3 offset:24576
    ds_read_b64_tr_b16 v[38:39], v3 offset:25088
    s_waitcnt lgkmcnt(10)
    v_mfma_f32_32x32x16_bf16 v[80:95], v[48:51], v[232:235], v[80:95]
    ds_read_b64_tr_b16 v[40:41], v4 offset:26624
    ds_read_b64_tr_b16 v[42:43], v4 offset:27136
    s_waitcnt lgkmcnt(10)
    v_mfma_f32_32x32x16_bf16 v[64:79], v[52:55], v[232:235], v[64:79]
    ds_read_b64_tr_b16 v[44:45], v3 offset:26624
    ds_read_b64_tr_b16 v[46:47], v3 offset:27136
    s_waitcnt lgkmcnt(10)
    v_mfma_f32_32x32x16_bf16 v[80:95], v[56:59], v[236:239], v[80:95]
    ds_read_b64_tr_b16 v[48:49], v4 offset:28672
    ds_read_b64_tr_b16 v[50:51], v4 offset:29184
    s_waitcnt lgkmcnt(10)
    v_mfma_f32_32x32x16_bf16 v[64:79], v[60:63], v[236:239], v[64:79]
    ds_read_b64_tr_b16 v[52:53], v3 offset:28672
    ds_read_b64_tr_b16 v[54:55], v3 offset:29184
    s_waitcnt lgkmcnt(10)
    v_mfma_f32_32x32x16_bf16 v[80:95], v[32:35], v[240:243], v[80:95]
    ds_read_b64_tr_b16 v[56:57], v4 offset:30720
    ds_read_b64_tr_b16 v[58:59], v4 offset:31232
    s_waitcnt lgkmcnt(10)
    v_mfma_f32_32x32x16_bf16 v[64:79], v[36:39], v[240:243], v[64:79]
    ds_read_b64_tr_b16 v[60:61], v3 offset:30720
    ds_read_b64_tr_b16 v[62:63], v3 offset:31232
    s_waitcnt lgkmcnt(10)
    v_mfma_f32_32x32x16_bf16 v[80:95], v[40:43], v[244:247], v[80:95]
    ds_read_b64_tr_b16 v[32:33], v30 offset:0
    ds_read_b64_tr_b16 v[34:35], v30 offset:512
    s_waitcnt lgkmcnt(10)
    v_mfma_f32_32x32x16_bf16 v[64:79], v[44:47], v[244:247], v[64:79]
    ds_read_b64_tr_b16 v[36:37], v9 offset:0
    ds_read_b64_tr_b16 v[38:39], v9 offset:512
    s_waitcnt lgkmcnt(10)
    v_mfma_f32_32x32x16_bf16 v[80:95], v[48:51], v[248:251], v[80:95]
    ds_read_b64_tr_b16 v[40:41], v30 offset:2048
    ds_read_b64_tr_b16 v[42:43], v30 offset:2560
    s_waitcnt lgkmcnt(10)
    v_mfma_f32_32x32x16_bf16 v[64:79], v[52:55], v[248:251], v[64:79]
    ds_read_b64_tr_b16 v[44:45], v9 offset:2048
    ds_read_b64_tr_b16 v[46:47], v9 offset:2560
    s_waitcnt lgkmcnt(10)
    v_mfma_f32_32x32x16_bf16 v[80:95], v[56:59], v[252:255], v[80:95]
    ds_read_b64_tr_b16 v[48:49], v30 offset:4096
    ds_read_b64_tr_b16 v[50:51], v30 offset:4608
    s_waitcnt lgkmcnt(10)
    v_mfma_f32_32x32x16_bf16 v[64:79], v[60:63], v[252:255], v[64:79]
    ds_read_b64_tr_b16 v[52:53], v9 offset:4096
    ds_read_b64_tr_b16 v[54:55], v9 offset:4608
    s_waitcnt vmcnt(10)
    s_waitcnt lgkmcnt(10)
    v_mfma_f32_32x32x16_bf16 v[80:95], v[32:35], v[128:131], v[80:95]
    ds_read_b64_tr_b16 v[56:57], v30 offset:6144
    ds_read_b64_tr_b16 v[58:59], v30 offset:6656
    s_waitcnt lgkmcnt(10)
    v_mfma_f32_32x32x16_bf16 v[64:79], v[36:39], v[128:131], v[64:79]
    ds_read_b64_tr_b16 v[60:61], v9 offset:6144
    ds_read_b64_tr_b16 v[62:63], v9 offset:6656
    ds_read_b32 v16, v6 offset:176
    s_waitcnt vmcnt(9)
    s_waitcnt lgkmcnt(11)
    v_mfma_f32_32x32x16_bf16 v[80:95], v[40:43], v[132:135], v[80:95]
    ds_read_b64_tr_b16 v[32:33], v30 offset:8192
    ds_read_b64_tr_b16 v[34:35], v30 offset:8704
    s_waitcnt lgkmcnt(11)
    v_mfma_f32_32x32x16_bf16 v[64:79], v[44:47], v[132:135], v[64:79]
    ds_read_b64_tr_b16 v[36:37], v9 offset:8192
    ds_read_b64_tr_b16 v[38:39], v9 offset:8704
    s_waitcnt vmcnt(8)
    s_waitcnt lgkmcnt(11)
    v_mfma_f32_32x32x16_bf16 v[80:95], v[48:51], v[136:139], v[80:95]
    ds_read_b64_tr_b16 v[40:41], v30 offset:10240
    ds_read_b64_tr_b16 v[42:43], v30 offset:10752
    s_waitcnt lgkmcnt(11)
    v_mfma_f32_32x32x16_bf16 v[64:79], v[52:55], v[136:139], v[64:79]
    ds_read_b64_tr_b16 v[44:45], v9 offset:10240
    ds_read_b64_tr_b16 v[46:47], v9 offset:10752
    s_waitcnt vmcnt(7)
    s_waitcnt lgkmcnt(11)
    v_mfma_f32_32x32x16_bf16 v[80:95], v[56:59], v[140:143], v[80:95]
    s_waitcnt lgkmcnt(8)
    v_cmp_ne_u32 vcc, 0x01010101, v16
    s_cbranch_vccnz Lspin_193
Lspinb_194:
    ds_read_b64_tr_b16 v[48:49], v25 offset:0
    ds_read_b64_tr_b16 v[50:51], v25 offset:512
    v_mfma_f32_32x32x16_bf16 v[64:79], v[60:63], v[140:143], v[64:79]
    ds_read_b64_tr_b16 v[52:53], v24 offset:0
    ds_read_b64_tr_b16 v[54:55], v24 offset:512
    s_waitcnt vmcnt(6)
    s_waitcnt lgkmcnt(10)
    v_mfma_f32_32x32x16_bf16 v[80:95], v[32:35], v[144:147], v[80:95]
    ds_read_b64_tr_b16 v[56:57], v25 offset:2048
    ds_read_b64_tr_b16 v[58:59], v25 offset:2560
    s_waitcnt lgkmcnt(10)
    v_mfma_f32_32x32x16_bf16 v[64:79], v[36:39], v[144:147], v[64:79]
    ds_read_b64_tr_b16 v[60:61], v24 offset:2048
    ds_read_b64_tr_b16 v[62:63], v24 offset:2560
    s_waitcnt vmcnt(5)
    s_waitcnt lgkmcnt(10)
    v_mfma_f32_32x32x16_bf16 v[80:95], v[40:43], v[148:151], v[80:95]
    ds_read_b64_tr_b16 v[32:33], v25 offset:4096
    ds_read_b64_tr_b16 v[34:35], v25 offset:4608
    s_waitcnt lgkmcnt(10)
    v_mfma_f32_32x32x16_bf16 v[64:79], v[44:47], v[148:151], v[64:79]
    ds_read_b64_tr_b16 v[36:37], v24 offset:4096
    ds_read_b64_tr_b16 v[38:39], v24 offset:4608
    s_waitcnt vmcnt(4)
    s_waitcnt lgkmcnt(10)
    v_mfma_f32_32x32x16_bf16 v[80:95], v[48:51], v[152:155], v[80:95]
    ds_read_b64_tr_b16 v[40:41], v25 offset:6144
    ds_read_b64_tr_b16 v[42:43], v25 offset:6656
    s_waitcnt lgkmcnt(10)
    v_mfma_f32_32x32x16_bf16 v[64:79], v[52:55], v[152:155], v[64:79]
    ds_read_b64_tr_b16 v[44:45], v24 offset:6144
    ds_read_b64_tr_b16 v[46:47], v24 offset:6656
    s_waitcnt vmcnt(3)
    s_waitcnt lgkmcnt(10)
    v_mfma_f32_32x32x16_bf16 v[80:95], v[56:59], v[156:159], v[80:95]
    ds_read_b64_tr_b16 v[48:49], v25 offset:8192
    ds_read_b64_tr_b16 v[50:51], v25 offset:8704
    s_waitcnt lgkmcnt(10)
    v_mfma_f32_32x32x16_bf16 v[64:79], v[60:63], v[156:159], v[64:79]
    ds_read_b64_tr_b16 v[52:53], v24 offset:8192
    ds_read_b64_tr_b16 v[54:55], v24 offset:8704
    s_waitcnt vmcnt(2)
    s_waitcnt lgkmcnt(10)
    v_mfma_f32_32x32x16_bf16 v[80:95], v[32:35], v[160:163], v[80:95]
    s_waitcnt lgkmcnt(8)
    v_mfma_f32_32x32x16_bf16 v[64:79], v[36:39], v[160:163], v[64:79]
    s_waitcnt vmcnt(1)
    s_waitcnt lgkmcnt(6)
    v_mfma_f32_32x32x16_bf16 v[80:95], v[40:43], v[164:167], v[80:95]
    s_waitcnt lgkmcnt(4)
    v_mfma_f32_32x32x16_bf16 v[64:79], v[44:47], v[164:167], v[64:79]
    s_waitcnt vmcnt(0)
    s_waitcnt lgkmcnt(2)
    v_mfma_f32_32x32x16_bf16 v[80:95], v[48:51], v[168:171], v[80:95]
    s_waitcnt lgkmcnt(0)
    v_mfma_f32_32x32x16_bf16 v[64:79], v[52:55], v[168:171], v[64:79]
    s_nop 9
    ds_write_b128 v11, v[80:83] offset:0
    ds_write_b128 v11, v[84:87] offset:1024
    ds_write_b128 v11, v[88:91] offset:2048
    ds_write_b128 v11, v[92:95] offset:3072
    ds_write_b8 v5, v7 offset:224
    ds_read_b128 v[192:195], v27 offset:768
    ds_read_b128 v[196:199], v27 offset:800
    ds_read_b128 v[200:203], v27 offset:832
    ds_read_b128 v[204:207], v27 offset:864
Lx_195:
    ds_read_u8 v16, v13 offset:224
    ds_read_b128 v[80:83], v12 offset:0
    ds_read_b128 v[84:87], v12 offset:1024
    ds_read_b128 v[88:91], v12 offset:2048
    ds_read_b128 v[92:95], v12 offset:3072
    s_waitcnt lgkmcnt(4)
    v_cmp_eq_u32 vcc, 0, v16
    s_cbranch_vccz Lxd_196
    s_sub_u32 s77, s77, 1
    s_cbranch_scc1 L_end
    s_branch Lx_195
Lxd_196:
    s_waitcnt lgkmcnt(3)
    v_pk_add_f32 v[64:65], v[64:65], v[80:81]
    v_pk_add_f32 v[66:67], v[66:67], v[82:83]
    s_waitcnt lgkmcnt(2)
    v_pk_add_f32 v[68:69], v[68:69], v[84:85]
    v_pk_add_f32 v[70:71], v[70:71], v[86:87]
    s_waitcnt lgkmcnt(1)
    v_pk_add_f32 v[72:73], v[72:73], v[88:89]
    v_pk_add_f32 v[74:75], v[74:75], v[90:91]
    s_waitcnt lgkmcnt(0)
    v_pk_add_f32 v[76:77], v[76:77], v[92:93]
    v_pk_add_f32 v[78:79], v[78:79], v[94:95]
    v_pk_fma_f32 v[96:97], v[64:65], v[192:193], v[96:97]
    v_pk_fma_f32 v[98:99], v[66:67], v[194:195], v[98:99]
    v_pk_fma_f32 v[100:101], v[68:69], v[196:197], v[100:101]
    v_pk_fma_f32 v[102:103], v[70:71], v[198:199], v[102:103]
    v_pk_fma_f32 v[104:105], v[72:73], v[200:201], v[104:105]
    v_pk_fma_f32 v[106:107], v[74:75], v[202:203], v[106:107]
    v_pk_fma_f32 v[108:109], v[76:77], v[204:205], v[108:109]
    v_pk_fma_f32 v[110:111], v[78:79], v[206:207], v[110:111]
    v_cvt_pk_bf16_f32 v112, v96, v97
    v_cvt_pk_bf16_f32 v113, v98, v99
    v_cvt_pk_bf16_f32 v114, v100, v101
    v_cvt_pk_bf16_f32 v115, v102, v103
    v_cvt_pk_bf16_f32 v116, v104, v105
    v_cvt_pk_bf16_f32 v117, v106, v107
    v_cvt_pk_bf16_f32 v118, v108, v109
    v_cvt_pk_bf16_f32 v119, v110, v111
    v_permlane32_swap_b32 v112, v114
    v_permlane32_swap_b32 v113, v115
    v_permlane32_swap_b32 v116, v118
    v_permlane32_swap_b32 v117, v119
    buffer_store_dwordx4 v[112:115], v10, s[68:71], s100 offen
    buffer_store_dwordx4 v[116:119], v10, s[68:71], s100 offen offset:32
    s_or_b32 s3, s2, s74
    s_cmp_lg_u32 s3, 0
    s_cbranch_scc1 Lne_197
    buffer_store_dword v14, v15, s[44:47], 0 offen
Lne_197:
L_end:
    s_endpgm
Lsafe_65:
    s_mov_b64 exec, 1
    buffer_store_dword v28, v29, s[44:47], s71 offen sc1
    s_mov_b64 exec, -1
    s_branch Lback_66
Lspin_80:
    ds_read_b32 v20, v8 offset:576
    s_waitcnt lgkmcnt(0)
    v_cmp_ne_u32 vcc, 0x01010101, v20
    s_cbranch_vccz Lspinb_81
    s_sub_u32 s77, s77, 1
    s_cbranch_scc1 L_end
    s_branch Lspin_80
Lsafe_82:
    buffer_store_dwordx4 v[24:27], v2, s[44:47], s10 offen sc1
    buffer_store_dwordx4 v[28:31], v2, s[44:47], s10 offen offset:1024 sc1
    s_branch Lback_83
Lsafe_84:
    s_mov_b64 exec, 1
    buffer_store_dword v12, v13, s[44:47], s11 offen sc1
    s_mov_b64 exec, -1
    s_branch Lback_85
Lspin_86:
    ds_read_b32 v20, v8 offset:128
    s_waitcnt lgkmcnt(0)
    v_cmp_ne_u32 vcc, 0x01010101, v20
    s_cbranch_vccz Lspinb_87
    s_sub_u32 s77, s77, 1
    s_cbranch_scc1 L_end
    s_branch Lspin_86
Lchk_88:
    buffer_load_dword v6, v4, s[44:47], s9 offen sc1
    s_waitcnt vmcnt(0)
    v_cmp_ne_u32 vcc, s75, v6
    s_cbranch_vccz Lchkb_89
    s_sub_u32 s77, s77, 1
    s_cbranch_scc1 L_end
    s_branch Lchk_88
Lsafe_90:
    buffer_store_dwordx4 v[24:27], v2, s[44:47], s10 offen sc1
    buffer_store_dwordx4 v[28:31], v2, s[44:47], s10 offen offset:1024 sc1
    s_branch Lback_91
Lsafe_92:
    s_mov_b64 exec, 1
    buffer_store_dword v12, v13, s[44:47], s11 offen sc1
    s_mov_b64 exec, -1
    s_branch Lback_93
Lchk_95:
    buffer_load_dword v6, v4, s[44:47], s9 offen sc1
    s_waitcnt vmcnt(0)
    v_cmp_ne_u32 vcc, s75, v6
    s_cbranch_vccz Lchkb_96
    s_sub_u32 s77, s77, 1
    s_cbranch_scc1 L_end
    s_branch Lchk_95
Lsafe_97:
    buffer_store_dwordx4 v[24:27], v2, s[44:47], s10 offen offset:0 sc1
    s_branch Lback_98
Lsafe_99:
    buffer_store_dwordx4 v[28:31], v2, s[44:47], s10 offen offset:1024 sc1
    s_branch Lback_100
Lsafe_101:
    s_mov_b64 exec, 1
    buffer_store_dword v12, v13, s[44:47], s11 offen sc1
    s_mov_b64 exec, -1
    s_branch Lback_102
Lsafe_119:
    s_mov_b64 exec, 1
    buffer_store_dword v14, v15, s[44:47], s5 offen sc1
    s_mov_b64 exec, -1
    s_branch Lback_120
Lsafe_138:
    buffer_store_dwordx2 v[120:121], v2, s[44:47], s10 offen sc1
    s_branch Lback_139
Lsafe_144:
    buffer_store_dwordx4 v[112:115], v2, s[44:47], s70 offen offset:0 sc1
    s_branch Lback_145
Lsafe_146:
    buffer_store_dwordx4 v[116:119], v2, s[44:47], s70 offen offset:1024 sc1
    s_branch Lback_147
Lsafe_148:
    s_mov_b64 exec, 1
    buffer_store_dword v14, v15, s[44:47], s97 offen sc1
    s_mov_b64 exec, -1
    s_branch Lback_149
Lpoll_164:
    buffer_load_dword v22, v21, s[44:47], s11 offen sc1
    s_waitcnt vmcnt(0)
    v_cmp_ne_u32 vcc, s75, v22
    s_cbranch_vccz Lpollb_165
    s_sleep 4
    s_sub_u32 s77, s77, 1
    s_cbranch_scc1 L_end
    s_branch Lpoll_164
Lpoll_187:
    buffer_load_dword v22, v21, s[44:47], s11 offen sc1
    s_waitcnt vmcnt(0)
    v_cmp_ne_u32 vcc, s75, v22
    s_cbranch_vccz Lpollb_188
    s_sleep 4
    s_sub_u32 s77, s77, 1
    s_cbranch_scc1 L_end
    s_branch Lpoll_187
Lspin_189:
    ds_read_b32 v16, v6 offset:160
    s_waitcnt lgkmcnt(0)
    v_cmp_ne_u32 vcc, 0x01010101, v16
    s_cbranch_vccz Lspinb_190
    s_sub_u32 s77, s77, 1
    s_cbranch_scc1 L_end
    s_branch Lspin_189
Lpoll_191:
    buffer_load_dword v22, v26, s[44:47], s11 offen sc1
    s_waitcnt vmcnt(0)
    v_cmp_ne_u32 vcc, s75, v22
    s_cbranch_vccz Lpollb_192
    s_sub_u32 s77, s77, 1
    s_cbranch_scc1 L_end
    s_branch Lpoll_191
Lspin_193:
    ds_read_b32 v16, v6 offset:176
    s_waitcnt lgkmcnt(0)
    v_cmp_ne_u32 vcc, 0x01010101, v16
    s_cbranch_vccz Lspinb_194
    s_sub_u32 s77, s77, 1
    s_cbranch_scc1 L_end
    s_branch Lspin_193
L_codeend:
.section .rodata,"a"
.p2align 6
.amdhsa_kernel adaLN_cond__linear_kernel_hedgehog__glu_gated_reglu__prompt_kernel
  .amdhsa_next_free_vgpr 256
  .amdhsa_next_free_sgpr 102
  .amdhsa_accum_offset 256
  .amdhsa_group_segment_fixed_size 0
  .amdhsa_kernarg_size 104
  .amdhsa_user_sgpr_count 2
  .amdhsa_user_sgpr_kernarg_segment_ptr 1
  .amdhsa_system_sgpr_workgroup_id_x 1
  .amdhsa_float_denorm_mode_32 3
.end_amdhsa_kernel
```
